```python
import torch

def _softmax(x, axis=-1):
    return torch.softmax(x, dim=axis)
def _gelu(x):
    return torch.nn.functional.gelu(x, approximate="tanh")
def _silu(x):
    return torch.nn.functional.silu(x)
def _sigmoid(x):
    return torch.sigmoid(x)
def _layernorm(x, axis=-1, eps=1e-5):
    m = x.mean(dim=axis, keepdim=True)
    v = x.var(dim=axis, keepdim=True, unbiased=False)
    return (x - m) / torch.sqrt(v + eps)
def _scatter_add(tgt, idx, src, axis=0):
    return tgt.clone().index_add_(axis, idx, src)
def _segment_sum(src, seg, n):
    out = torch.zeros((n,) + src.shape[1:], dtype=src.dtype)
    return out.index_add_(0, seg, src)
def _pad(x, pw):
    flat = tuple(v for pair in reversed(pw) for v in pair)
    return torch.nn.functional.pad(x, flat)

kernel_name = 'parallel_sum__sliding_block_cached__mixer_token_mlp__decode'

def setup_inputs():

    _w = (lambda a: (lambda t: t.to(torch.bfloat16) if t.is_floating_point() else t)(torch.as_tensor(a)))
    def _A_setup():
        B, Sq, D = 1, 1, 448
        Hq, Hkv, Sk, Dh = 16, 8, 32768, 256
        assert Hq % Hkv == 0, (Hq, Hkv)
        return {
            "x": _w((lambda *s: torch.randn(*s, dtype=torch.bfloat16) * 0.05)(B, Sq, D)),
            "k_cache": _w((lambda *s: torch.randn(*s, dtype=torch.bfloat16) * 1.6)(B, Hkv, Sk, Dh)),
            "v_cache": _w((lambda *s: torch.randn(*s, dtype=torch.bfloat16) * 0.8)(B, Hkv, Sk, Dh)),
            "wq": _w((lambda *s: torch.randn(*s, dtype=torch.bfloat16) * 1.6)(D, Hq * Dh) * (D ** -0.5)),
            "wo": _w((lambda *s: torch.randn(*s, dtype=torch.bfloat16) * 0.8)(Hq * Dh, D) * ((Hq * Dh) ** -0.5)),
        }
    _A_in = _A_setup()

    def _B_setup():
        B, S, D, F = 1, 1, 448, 1792
        return {
            "x": _w((lambda *s: torch.randn(*s, dtype=torch.bfloat16) * 0.05)(B, S, D)),
            "w1": _w((lambda *s: torch.randn(*s, dtype=torch.bfloat16) * 0.4)(S, F) * (S ** -0.5)),
            "b1": _w((lambda *s: torch.randn(*s, dtype=torch.bfloat16) * 0.4)(F) * 0.02),
            "w2": _w((lambda *s: torch.randn(*s, dtype=torch.bfloat16) * 0.4)(F, S) * (F ** -0.5)),
            "b2": _w((lambda *s: torch.randn(*s, dtype=torch.bfloat16) * 0.4)(S) * 0.02),
        }
    _B_in = _B_setup()

    return {
        "A_x": _A_in["x"],
        "A_k_cache": _A_in["k_cache"],
        "A_v_cache": _A_in["v_cache"],
        "A_wq": _A_in["wq"],
        "A_wo": _A_in["wo"],
        "B_x": _B_in["x"],
        "B_w1": _B_in["w1"],
        "B_b1": _B_in["b1"],
        "B_w2": _B_in["w2"],
        "B_b2": _B_in["b2"],
    }

def reference(A_x, A_k_cache, A_v_cache, A_wq, A_wo, B_x, B_w1, B_b1, B_w2, B_b2):
    def _A_ref(x, k_cache, v_cache, wq, wo):
        B, Sq, D = x.shape
        Hq, Dh = 16, 256
        Hkv, Sk = k_cache.shape[1], k_cache.shape[2]
        W = min(4096, max(256, Sk // 4))
        rep = Hq // Hkv
        q = (lambda x, *d: x.permute(*d))((x @ wq).reshape(B, Sq, Hq, Dh), 0, 2, 1, 3)
        k = (lambda x, n, axis: torch.repeat_interleave(x, n, dim=axis))(k_cache[:, :, Sk - W:, :], rep, axis=1)
        v = (lambda x, n, axis: torch.repeat_interleave(x, n, dim=axis))(v_cache[:, :, Sk - W:, :], rep, axis=1)
        scores = torch.einsum("bhqd,bhkd->bhqk", q, k) * (Dh ** -0.5)
        p = _softmax(scores, axis=-1)
        o = torch.einsum("bhqk,bhkd->bhqd", p, v)
        return (lambda x, *d: x.permute(*d))(o, 0, 2, 1, 3).reshape(B, Sq, Hq * Dh) @ wo

    def _B_ref(x, w1, b1, w2, b2):
        B, S, D = x.shape
        h = _layernorm(x, axis=-1)
        u = torch.einsum("bsd,sf->bdf", h, w1) + b1
        u = _gelu(u)
        y = torch.einsum("bdf,fs->bds", u, w2) + b2
        return (lambda x, *d: x.permute(*d))(y, 0, 2, 1)

    x = A_x
    xn = _layernorm(x, axis=-1)
    return x + _A_ref(xn, A_k_cache, A_v_cache, A_wq, A_wo) + _B_ref(xn, B_w1, B_b1, B_w2, B_b2)
```

```asm
; @launch grid=(256,1,1) block=(320,1,1) lds=63552
.amdgcn_target "amdgcn-amd-amdhsa--gfx950"
.text
.globl parallel_sum__sliding_block_cached__mixer_token_mlp__decode_kernel
.p2align 8
.type parallel_sum__sliding_block_cached__mixer_token_mlp__decode_kernel,@function
parallel_sum__sliding_block_cached__mixer_token_mlp__decode_kernel:
  s_cmp_ge_u32 s2, 256
  s_cbranch_scc1 END
  s_load_dwordx16 s[64:79], s[0:1], 0
  s_load_dwordx8 s[80:87], s[0:1], 64
  s_load_dwordx2 s[88:89], s[0:1], 96
  v_lshrrev_b32 v1, 6, v0
  v_and_b32 v2, 63, v0
  s_nop 0
  v_readfirstlane_b32 s3, v1
  s_waitcnt lgkmcnt(0)
  s_mov_b32 s20, s88
  s_and_b32 s21, s89, 0xffff
  s_mov_b32 s22, 0x20000000
  s_mov_b32 s23, 0x00020000
  s_mov_b32 s40, s86
  s_and_b32 s41, s87, 0xffff
  s_mov_b32 s42, 0x100
  s_mov_b32 s43, 0x00020000
  s_lshr_b32 s90, s2, 5
  s_and_b32 s91, s2, 31
  s_cmp_eq_u32 s3, 4
  s_cbranch_scc1 W4
  s_mov_b32 s12, s66
  s_and_b32 s13, s67, 0xffff
  s_mov_b32 s14, 0x8000000
  s_mov_b32 s15, 0x00020000
  s_mov_b32 s16, s68
  s_and_b32 s17, s69, 0xffff
  s_mov_b32 s18, 0x8000000
  s_mov_b32 s19, 0x00020000
  s_mov_b32 s28, s72
  s_and_b32 s29, s73, 0xffff
  s_mov_b32 s30, 0x380000
  s_mov_b32 s31, 0x00020000
  s_lshl_b32 s26, s90, 24
  s_lshl_b32 s27, s91, 16
  s_add_u32 s26, s26, s27
  s_add_u32 s26, s26, 14680064
  v_lshlrev_b32 v3, 14, v1
  v_lshl_add_u32 v3, v2, 4, v3
  s_mov_b32 s44, s64
  s_and_b32 s45, s65, 0xffff
  s_mov_b32 s46, 0x380
  s_mov_b32 s47, 0x00020000
  s_mov_b32 s48, s76
  s_and_b32 s49, s77, 0xffff
  s_mov_b32 s50, 0xe00
  s_mov_b32 s51, 0x00020000
  s_mov_b32 s52, s78
  s_and_b32 s53, s79, 0xffff
  s_mov_b32 s54, 0xe00
  s_mov_b32 s55, 0x00020000
  s_mov_b32 s32, s80
  s_and_b32 s33, s81, 0xffff
  s_mov_b32 s34, 0xe00
  s_mov_b32 s35, 0x00020000
  v_lshlrev_b32 v4, 1, v2
  buffer_load_ushort v10, v4, s[44:47], 0 offen offset:0
  buffer_load_ushort v11, v4, s[44:47], 0 offen offset:128
  buffer_load_ushort v12, v4, s[44:47], 0 offen offset:256
  buffer_load_ushort v13, v4, s[44:47], 0 offen offset:384
  buffer_load_ushort v14, v4, s[44:47], 0 offen offset:512
  buffer_load_ushort v15, v4, s[44:47], 0 offen offset:640
  buffer_load_ushort v16, v4, s[44:47], 0 offen offset:768
  s_mul_i32 s60, s2, 14
  v_lshl_add_u32 v4, v1, 1, s60
  buffer_load_ushort v40, v4, s[48:51], 0 offen offset:0
  buffer_load_ushort v42, v4, s[52:55], 0 offen offset:0
  buffer_load_ushort v44, v4, s[32:35], 0 offen offset:0
  buffer_load_ushort v41, v4, s[48:51], 0 offen offset:8
  buffer_load_ushort v43, v4, s[52:55], 0 offen offset:8
  buffer_load_ushort v45, v4, s[32:35], 0 offen offset:8
  s_waitcnt vmcnt(0)
  v_lshlrev_b32 v10, 16, v10
  v_lshlrev_b32 v11, 16, v11
  v_lshlrev_b32 v12, 16, v12
  v_lshlrev_b32 v13, 16, v13
  v_lshlrev_b32 v14, 16, v14
  v_lshlrev_b32 v15, 16, v15
  v_lshlrev_b32 v16, 16, v16
  v_lshlrev_b32 v40, 16, v40
  v_lshlrev_b32 v41, 16, v41
  v_lshlrev_b32 v42, 16, v42
  v_lshlrev_b32 v43, 16, v43
  v_lshlrev_b32 v44, 16, v44
  v_lshlrev_b32 v45, 16, v45
  v_cmp_eq_u32 vcc, 3, v1
  s_nop 1
  v_cndmask_b32 v45, v45, 0, vcc
  v_mov_b32 v17, v10
  v_add_f32 v17, v17, v11
  v_add_f32 v17, v17, v12
  v_add_f32 v17, v17, v13
  v_add_f32 v17, v17, v14
  v_add_f32 v17, v17, v15
  v_add_f32 v17, v17, v16
  s_nop 1
  v_add_f32 v17, v17, v17 quad_perm:[1,0,3,2] row_mask:0xf bank_mask:0xf
  s_nop 1
  v_add_f32 v17, v17, v17 quad_perm:[2,3,0,1] row_mask:0xf bank_mask:0xf
  s_nop 1
  v_add_f32 v17, v17, v17 row_ror:4 row_mask:0xf bank_mask:0xf
  s_nop 1
  v_add_f32 v17, v17, v17 row_ror:8 row_mask:0xf bank_mask:0xf
  s_nop 1
  v_readlane_b32 s56, v17, 0
  v_readlane_b32 s57, v17, 16
  v_readlane_b32 s58, v17, 32
  v_readlane_b32 s59, v17, 48
  s_nop 1
  v_mov_b32 v17, s56
  v_add_f32 v17, s57, v17
  v_add_f32 v17, s58, v17
  v_add_f32 v17, s59, v17
  v_mul_f32 v17, 0.002232142857142857, v17
  v_mov_b32 v18, 0
  v_sub_f32 v19, v10, v17
  v_fmac_f32 v18, v19, v19
  v_sub_f32 v19, v11, v17
  v_fmac_f32 v18, v19, v19
  v_sub_f32 v19, v12, v17
  v_fmac_f32 v18, v19, v19
  v_sub_f32 v19, v13, v17
  v_fmac_f32 v18, v19, v19
  v_sub_f32 v19, v14, v17
  v_fmac_f32 v18, v19, v19
  v_sub_f32 v19, v15, v17
  v_fmac_f32 v18, v19, v19
  v_sub_f32 v19, v16, v17
  v_fmac_f32 v18, v19, v19
  s_nop 1
  v_add_f32 v18, v18, v18 quad_perm:[1,0,3,2] row_mask:0xf bank_mask:0xf
  s_nop 1
  v_add_f32 v18, v18, v18 quad_perm:[2,3,0,1] row_mask:0xf bank_mask:0xf
  s_nop 1
  v_add_f32 v18, v18, v18 row_ror:4 row_mask:0xf bank_mask:0xf
  s_nop 1
  v_add_f32 v18, v18, v18 row_ror:8 row_mask:0xf bank_mask:0xf
  s_nop 1
  v_readlane_b32 s56, v18, 0
  v_readlane_b32 s57, v18, 16
  v_readlane_b32 s58, v18, 32
  v_readlane_b32 s59, v18, 48
  s_nop 1
  v_mov_b32 v18, s56
  v_add_f32 v18, s57, v18
  v_add_f32 v18, s58, v18
  v_add_f32 v18, s59, v18
  v_mul_f32 v18, 0.002232142857142857, v18
  v_cvt_pk_bf16_f32 v17, v17, v17
  v_lshlrev_b32 v17, 16, v17
  v_cvt_pk_bf16_f32 v18, v18, v18
  v_lshlrev_b32 v18, 16, v18
  v_add_f32 v18, 1e-05, v18
  v_cvt_pk_bf16_f32 v18, v18, v18
  v_lshlrev_b32 v18, 16, v18
  v_sqrt_f32 v18, v18
  s_nop 0
  v_cvt_pk_bf16_f32 v18, v18, v18
  v_lshlrev_b32 v18, 16, v18
  v_rcp_f32 v18, v18
  s_nop 0
  v_sub_f32 v10, v10, v17
  v_cvt_pk_bf16_f32 v10, v10, v10
  v_lshlrev_b32 v10, 16, v10
  v_mul_f32 v10, v10, v18
  v_cvt_pk_bf16_f32 v10, v10, v10
  v_lshlrev_b32 v10, 16, v10
  v_sub_f32 v11, v11, v17
  v_cvt_pk_bf16_f32 v11, v11, v11
  v_lshlrev_b32 v11, 16, v11
  v_mul_f32 v11, v11, v18
  v_cvt_pk_bf16_f32 v11, v11, v11
  v_lshlrev_b32 v11, 16, v11
  v_sub_f32 v12, v12, v17
  v_cvt_pk_bf16_f32 v12, v12, v12
  v_lshlrev_b32 v12, 16, v12
  v_mul_f32 v12, v12, v18
  v_cvt_pk_bf16_f32 v12, v12, v12
  v_lshlrev_b32 v12, 16, v12
  v_sub_f32 v13, v13, v17
  v_cvt_pk_bf16_f32 v13, v13, v13
  v_lshlrev_b32 v13, 16, v13
  v_mul_f32 v13, v13, v18
  v_cvt_pk_bf16_f32 v13, v13, v13
  v_lshlrev_b32 v13, 16, v13
  v_sub_f32 v14, v14, v17
  v_cvt_pk_bf16_f32 v14, v14, v14
  v_lshlrev_b32 v14, 16, v14
  v_mul_f32 v14, v14, v18
  v_cvt_pk_bf16_f32 v14, v14, v14
  v_lshlrev_b32 v14, 16, v14
  v_sub_f32 v15, v15, v17
  v_cvt_pk_bf16_f32 v15, v15, v15
  v_lshlrev_b32 v15, 16, v15
  v_mul_f32 v15, v15, v18
  v_cvt_pk_bf16_f32 v15, v15, v15
  v_lshlrev_b32 v15, 16, v15
  v_sub_f32 v16, v16, v17
  v_cvt_pk_bf16_f32 v16, v16, v16
  v_lshlrev_b32 v16, 16, v16
  v_mul_f32 v16, v16, v18
  v_cvt_pk_bf16_f32 v16, v16, v16
  v_lshlrev_b32 v16, 16, v16
  v_mov_b32 v17, v10
  v_add_f32 v17, v17, v11
  v_add_f32 v17, v17, v12
  v_add_f32 v17, v17, v13
  v_add_f32 v17, v17, v14
  v_add_f32 v17, v17, v15
  v_add_f32 v17, v17, v16
  s_nop 1
  v_add_f32 v17, v17, v17 quad_perm:[1,0,3,2] row_mask:0xf bank_mask:0xf
  s_nop 1
  v_add_f32 v17, v17, v17 quad_perm:[2,3,0,1] row_mask:0xf bank_mask:0xf
  s_nop 1
  v_add_f32 v17, v17, v17 row_ror:4 row_mask:0xf bank_mask:0xf
  s_nop 1
  v_add_f32 v17, v17, v17 row_ror:8 row_mask:0xf bank_mask:0xf
  s_nop 1
  v_readlane_b32 s56, v17, 0
  v_readlane_b32 s57, v17, 16
  v_readlane_b32 s58, v17, 32
  v_readlane_b32 s59, v17, 48
  s_nop 1
  v_mov_b32 v17, s56
  v_add_f32 v17, s57, v17
  v_add_f32 v17, s58, v17
  v_add_f32 v17, s59, v17
  v_mul_f32 v17, 0.002232142857142857, v17
  v_mov_b32 v18, 0
  v_sub_f32 v19, v10, v17
  v_fmac_f32 v18, v19, v19
  v_sub_f32 v19, v11, v17
  v_fmac_f32 v18, v19, v19
  v_sub_f32 v19, v12, v17
  v_fmac_f32 v18, v19, v19
  v_sub_f32 v19, v13, v17
  v_fmac_f32 v18, v19, v19
  v_sub_f32 v19, v14, v17
  v_fmac_f32 v18, v19, v19
  v_sub_f32 v19, v15, v17
  v_fmac_f32 v18, v19, v19
  v_sub_f32 v19, v16, v17
  v_fmac_f32 v18, v19, v19
  s_nop 1
  v_add_f32 v18, v18, v18 quad_perm:[1,0,3,2] row_mask:0xf bank_mask:0xf
  s_nop 1
  v_add_f32 v18, v18, v18 quad_perm:[2,3,0,1] row_mask:0xf bank_mask:0xf
  s_nop 1
  v_add_f32 v18, v18, v18 row_ror:4 row_mask:0xf bank_mask:0xf
  s_nop 1
  v_add_f32 v18, v18, v18 row_ror:8 row_mask:0xf bank_mask:0xf
  s_nop 1
  v_readlane_b32 s56, v18, 0
  v_readlane_b32 s57, v18, 16
  v_readlane_b32 s58, v18, 32
  v_readlane_b32 s59, v18, 48
  s_nop 1
  v_mov_b32 v18, s56
  v_add_f32 v18, s57, v18
  v_add_f32 v18, s58, v18
  v_add_f32 v18, s59, v18
  v_mul_f32 v18, 0.002232142857142857, v18
  v_cvt_pk_bf16_f32 v17, v17, v17
  v_lshlrev_b32 v17, 16, v17
  v_cvt_pk_bf16_f32 v18, v18, v18
  v_lshlrev_b32 v18, 16, v18
  v_add_f32 v18, 1e-05, v18
  v_cvt_pk_bf16_f32 v18, v18, v18
  v_lshlrev_b32 v18, 16, v18
  v_sqrt_f32 v18, v18
  s_nop 0
  v_cvt_pk_bf16_f32 v18, v18, v18
  v_lshlrev_b32 v18, 16, v18
  v_rcp_f32 v18, v18
  s_nop 0
  v_sub_f32 v10, v10, v17
  v_cvt_pk_bf16_f32 v10, v10, v10
  v_lshlrev_b32 v10, 16, v10
  v_mul_f32 v10, v10, v18
  v_cvt_pk_bf16_f32 v10, v10, v10
  v_lshlrev_b32 v10, 16, v10
  v_sub_f32 v11, v11, v17
  v_cvt_pk_bf16_f32 v11, v11, v11
  v_lshlrev_b32 v11, 16, v11
  v_mul_f32 v11, v11, v18
  v_cvt_pk_bf16_f32 v11, v11, v11
  v_lshlrev_b32 v11, 16, v11
  v_sub_f32 v12, v12, v17
  v_cvt_pk_bf16_f32 v12, v12, v12
  v_lshlrev_b32 v12, 16, v12
  v_mul_f32 v12, v12, v18
  v_cvt_pk_bf16_f32 v12, v12, v12
  v_lshlrev_b32 v12, 16, v12
  v_sub_f32 v13, v13, v17
  v_cvt_pk_bf16_f32 v13, v13, v13
  v_lshlrev_b32 v13, 16, v13
  v_mul_f32 v13, v13, v18
  v_cvt_pk_bf16_f32 v13, v13, v13
  v_lshlrev_b32 v13, 16, v13
  v_sub_f32 v14, v14, v17
  v_cvt_pk_bf16_f32 v14, v14, v14
  v_lshlrev_b32 v14, 16, v14
  v_mul_f32 v14, v14, v18
  v_cvt_pk_bf16_f32 v14, v14, v14
  v_lshlrev_b32 v14, 16, v14
  v_sub_f32 v15, v15, v17
  v_cvt_pk_bf16_f32 v15, v15, v15
  v_lshlrev_b32 v15, 16, v15
  v_mul_f32 v15, v15, v18
  v_cvt_pk_bf16_f32 v15, v15, v15
  v_lshlrev_b32 v15, 16, v15
  v_sub_f32 v16, v16, v17
  v_cvt_pk_bf16_f32 v16, v16, v16
  v_lshlrev_b32 v16, 16, v16
  v_mul_f32 v16, v16, v18
  v_cvt_pk_bf16_f32 v16, v16, v16
  v_lshlrev_b32 v16, 16, v16
  v_mov_b32 v24, 0
  v_mov_b32 v25, 0
  v_mov_b32 v26, 0
  v_mov_b32 v27, 0
  v_mov_b32 v28, 0
  v_mov_b32 v29, 0
  v_mov_b32 v30, 0
  v_mul_f32 v55, v10, v40
  v_cvt_pk_bf16_f32 v55, v55, v55
  v_lshlrev_b32 v55, 16, v55
  v_add_f32 v55, v55, v42
  v_cvt_pk_bf16_f32 v55, v55, v55
  v_lshlrev_b32 v55, 16, v55
  v_mul_f32 v56, v55, v55
  v_mul_f32 v56, v56, v55
  v_mul_f32 v56, 0.044715, v56
  v_add_f32 v56, v56, v55
  v_mul_f32 v56, 2.302208198144325, v56
  v_exp_f32 v56, v56
  s_nop 0
  v_add_f32 v56, 1.0, v56
  v_rcp_f32 v56, v56
  s_nop 0
  v_sub_f32 v56, 1.0, v56
  v_mul_f32 v56, v56, v55
  v_cvt_pk_bf16_f32 v56, v56, v56
  v_lshlrev_b32 v56, 16, v56
  v_fmac_f32 v24, v56, v44
  v_mul_f32 v55, v11, v40
  v_cvt_pk_bf16_f32 v55, v55, v55
  v_lshlrev_b32 v55, 16, v55
  v_add_f32 v55, v55, v42
  v_cvt_pk_bf16_f32 v55, v55, v55
  v_lshlrev_b32 v55, 16, v55
  v_mul_f32 v56, v55, v55
  v_mul_f32 v56, v56, v55
  v_mul_f32 v56, 0.044715, v56
  v_add_f32 v56, v56, v55
  v_mul_f32 v56, 2.302208198144325, v56
  v_exp_f32 v56, v56
  s_nop 0
  v_add_f32 v56, 1.0, v56
  v_rcp_f32 v56, v56
  s_nop 0
  v_sub_f32 v56, 1.0, v56
  v_mul_f32 v56, v56, v55
  v_cvt_pk_bf16_f32 v56, v56, v56
  v_lshlrev_b32 v56, 16, v56
  v_fmac_f32 v25, v56, v44
  v_mul_f32 v55, v12, v40
  v_cvt_pk_bf16_f32 v55, v55, v55
  v_lshlrev_b32 v55, 16, v55
  v_add_f32 v55, v55, v42
  v_cvt_pk_bf16_f32 v55, v55, v55
  v_lshlrev_b32 v55, 16, v55
  v_mul_f32 v56, v55, v55
  v_mul_f32 v56, v56, v55
  v_mul_f32 v56, 0.044715, v56
  v_add_f32 v56, v56, v55
  v_mul_f32 v56, 2.302208198144325, v56
  v_exp_f32 v56, v56
  s_nop 0
  v_add_f32 v56, 1.0, v56
  v_rcp_f32 v56, v56
  s_nop 0
  v_sub_f32 v56, 1.0, v56
  v_mul_f32 v56, v56, v55
  v_cvt_pk_bf16_f32 v56, v56, v56
  v_lshlrev_b32 v56, 16, v56
  v_fmac_f32 v26, v56, v44
  v_mul_f32 v55, v13, v40
  v_cvt_pk_bf16_f32 v55, v55, v55
  v_lshlrev_b32 v55, 16, v55
  v_add_f32 v55, v55, v42
  v_cvt_pk_bf16_f32 v55, v55, v55
  v_lshlrev_b32 v55, 16, v55
  v_mul_f32 v56, v55, v55
  v_mul_f32 v56, v56, v55
  v_mul_f32 v56, 0.044715, v56
  v_add_f32 v56, v56, v55
  v_mul_f32 v56, 2.302208198144325, v56
  v_exp_f32 v56, v56
  s_nop 0
  v_add_f32 v56, 1.0, v56
  v_rcp_f32 v56, v56
  s_nop 0
  v_sub_f32 v56, 1.0, v56
  v_mul_f32 v56, v56, v55
  v_cvt_pk_bf16_f32 v56, v56, v56
  v_lshlrev_b32 v56, 16, v56
  v_fmac_f32 v27, v56, v44
  v_mul_f32 v55, v14, v40
  v_cvt_pk_bf16_f32 v55, v55, v55
  v_lshlrev_b32 v55, 16, v55
  v_add_f32 v55, v55, v42
  v_cvt_pk_bf16_f32 v55, v55, v55
  v_lshlrev_b32 v55, 16, v55
  v_mul_f32 v56, v55, v55
  v_mul_f32 v56, v56, v55
  v_mul_f32 v56, 0.044715, v56
  v_add_f32 v56, v56, v55
  v_mul_f32 v56, 2.302208198144325, v56
  v_exp_f32 v56, v56
  s_nop 0
  v_add_f32 v56, 1.0, v56
  v_rcp_f32 v56, v56
  s_nop 0
  v_sub_f32 v56, 1.0, v56
  v_mul_f32 v56, v56, v55
  v_cvt_pk_bf16_f32 v56, v56, v56
  v_lshlrev_b32 v56, 16, v56
  v_fmac_f32 v28, v56, v44
  v_mul_f32 v55, v15, v40
  v_cvt_pk_bf16_f32 v55, v55, v55
  v_lshlrev_b32 v55, 16, v55
  v_add_f32 v55, v55, v42
  v_cvt_pk_bf16_f32 v55, v55, v55
  v_lshlrev_b32 v55, 16, v55
  v_mul_f32 v56, v55, v55
  v_mul_f32 v56, v56, v55
  v_mul_f32 v56, 0.044715, v56
  v_add_f32 v56, v56, v55
  v_mul_f32 v56, 2.302208198144325, v56
  v_exp_f32 v56, v56
  s_nop 0
  v_add_f32 v56, 1.0, v56
  v_rcp_f32 v56, v56
  s_nop 0
  v_sub_f32 v56, 1.0, v56
  v_mul_f32 v56, v56, v55
  v_cvt_pk_bf16_f32 v56, v56, v56
  v_lshlrev_b32 v56, 16, v56
  v_fmac_f32 v29, v56, v44
  v_mul_f32 v55, v16, v40
  v_cvt_pk_bf16_f32 v55, v55, v55
  v_lshlrev_b32 v55, 16, v55
  v_add_f32 v55, v55, v42
  v_cvt_pk_bf16_f32 v55, v55, v55
  v_lshlrev_b32 v55, 16, v55
  v_mul_f32 v56, v55, v55
  v_mul_f32 v56, v56, v55
  v_mul_f32 v56, 0.044715, v56
  v_add_f32 v56, v56, v55
  v_mul_f32 v56, 2.302208198144325, v56
  v_exp_f32 v56, v56
  s_nop 0
  v_add_f32 v56, 1.0, v56
  v_rcp_f32 v56, v56
  s_nop 0
  v_sub_f32 v56, 1.0, v56
  v_mul_f32 v56, v56, v55
  v_cvt_pk_bf16_f32 v56, v56, v56
  v_lshlrev_b32 v56, 16, v56
  v_fmac_f32 v30, v56, v44
  v_mul_f32 v55, v10, v41
  v_cvt_pk_bf16_f32 v55, v55, v55
  v_lshlrev_b32 v55, 16, v55
  v_add_f32 v55, v55, v43
  v_cvt_pk_bf16_f32 v55, v55, v55
  v_lshlrev_b32 v55, 16, v55
  v_mul_f32 v56, v55, v55
  v_mul_f32 v56, v56, v55
  v_mul_f32 v56, 0.044715, v56
  v_add_f32 v56, v56, v55
  v_mul_f32 v56, 2.302208198144325, v56
  v_exp_f32 v56, v56
  s_nop 0
  v_add_f32 v56, 1.0, v56
  v_rcp_f32 v56, v56
  s_nop 0
  v_sub_f32 v56, 1.0, v56
  v_mul_f32 v56, v56, v55
  v_cvt_pk_bf16_f32 v56, v56, v56
  v_lshlrev_b32 v56, 16, v56
  v_fmac_f32 v24, v56, v45
  v_mul_f32 v55, v11, v41
  v_cvt_pk_bf16_f32 v55, v55, v55
  v_lshlrev_b32 v55, 16, v55
  v_add_f32 v55, v55, v43
  v_cvt_pk_bf16_f32 v55, v55, v55
  v_lshlrev_b32 v55, 16, v55
  v_mul_f32 v56, v55, v55
  v_mul_f32 v56, v56, v55
  v_mul_f32 v56, 0.044715, v56
  v_add_f32 v56, v56, v55
  v_mul_f32 v56, 2.302208198144325, v56
  v_exp_f32 v56, v56
  s_nop 0
  v_add_f32 v56, 1.0, v56
  v_rcp_f32 v56, v56
  s_nop 0
  v_sub_f32 v56, 1.0, v56
  v_mul_f32 v56, v56, v55
  v_cvt_pk_bf16_f32 v56, v56, v56
  v_lshlrev_b32 v56, 16, v56
  v_fmac_f32 v25, v56, v45
  v_mul_f32 v55, v12, v41
  v_cvt_pk_bf16_f32 v55, v55, v55
  v_lshlrev_b32 v55, 16, v55
  v_add_f32 v55, v55, v43
  v_cvt_pk_bf16_f32 v55, v55, v55
  v_lshlrev_b32 v55, 16, v55
  v_mul_f32 v56, v55, v55
  v_mul_f32 v56, v56, v55
  v_mul_f32 v56, 0.044715, v56
  v_add_f32 v56, v56, v55
  v_mul_f32 v56, 2.302208198144325, v56
  v_exp_f32 v56, v56
  s_nop 0
  v_add_f32 v56, 1.0, v56
  v_rcp_f32 v56, v56
  s_nop 0
  v_sub_f32 v56, 1.0, v56
  v_mul_f32 v56, v56, v55
  v_cvt_pk_bf16_f32 v56, v56, v56
  v_lshlrev_b32 v56, 16, v56
  v_fmac_f32 v26, v56, v45
  v_mul_f32 v55, v13, v41
  v_cvt_pk_bf16_f32 v55, v55, v55
  v_lshlrev_b32 v55, 16, v55
  v_add_f32 v55, v55, v43
  v_cvt_pk_bf16_f32 v55, v55, v55
  v_lshlrev_b32 v55, 16, v55
  v_mul_f32 v56, v55, v55
  v_mul_f32 v56, v56, v55
  v_mul_f32 v56, 0.044715, v56
  v_add_f32 v56, v56, v55
  v_mul_f32 v56, 2.302208198144325, v56
  v_exp_f32 v56, v56
  s_nop 0
  v_add_f32 v56, 1.0, v56
  v_rcp_f32 v56, v56
  s_nop 0
  v_sub_f32 v56, 1.0, v56
  v_mul_f32 v56, v56, v55
  v_cvt_pk_bf16_f32 v56, v56, v56
  v_lshlrev_b32 v56, 16, v56
  v_fmac_f32 v27, v56, v45
  v_mul_f32 v55, v14, v41
  v_cvt_pk_bf16_f32 v55, v55, v55
  v_lshlrev_b32 v55, 16, v55
  v_add_f32 v55, v55, v43
  v_cvt_pk_bf16_f32 v55, v55, v55
  v_lshlrev_b32 v55, 16, v55
  v_mul_f32 v56, v55, v55
  v_mul_f32 v56, v56, v55
  v_mul_f32 v56, 0.044715, v56
  v_add_f32 v56, v56, v55
  v_mul_f32 v56, 2.302208198144325, v56
  v_exp_f32 v56, v56
  s_nop 0
  v_add_f32 v56, 1.0, v56
  v_rcp_f32 v56, v56
  s_nop 0
  v_sub_f32 v56, 1.0, v56
  v_mul_f32 v56, v56, v55
  v_cvt_pk_bf16_f32 v56, v56, v56
  v_lshlrev_b32 v56, 16, v56
  v_fmac_f32 v28, v56, v45
  v_mul_f32 v55, v15, v41
  v_cvt_pk_bf16_f32 v55, v55, v55
  v_lshlrev_b32 v55, 16, v55
  v_add_f32 v55, v55, v43
  v_cvt_pk_bf16_f32 v55, v55, v55
  v_lshlrev_b32 v55, 16, v55
  v_mul_f32 v56, v55, v55
  v_mul_f32 v56, v56, v55
  v_mul_f32 v56, 0.044715, v56
  v_add_f32 v56, v56, v55
  v_mul_f32 v56, 2.302208198144325, v56
  v_exp_f32 v56, v56
  s_nop 0
  v_add_f32 v56, 1.0, v56
  v_rcp_f32 v56, v56
  s_nop 0
  v_sub_f32 v56, 1.0, v56
  v_mul_f32 v56, v56, v55
  v_cvt_pk_bf16_f32 v56, v56, v56
  v_lshlrev_b32 v56, 16, v56
  v_fmac_f32 v29, v56, v45
  v_mul_f32 v55, v16, v41
  v_cvt_pk_bf16_f32 v55, v55, v55
  v_lshlrev_b32 v55, 16, v55
  v_add_f32 v55, v55, v43
  v_cvt_pk_bf16_f32 v55, v55, v55
  v_lshlrev_b32 v55, 16, v55
  v_mul_f32 v56, v55, v55
  v_mul_f32 v56, v56, v55
  v_mul_f32 v56, 0.044715, v56
  v_add_f32 v56, v56, v55
  v_mul_f32 v56, 2.302208198144325, v56
  v_exp_f32 v56, v56
  s_nop 0
  v_add_f32 v56, 1.0, v56
  v_rcp_f32 v56, v56
  s_nop 0
  v_sub_f32 v56, 1.0, v56
  v_mul_f32 v56, v56, v55
  v_cvt_pk_bf16_f32 v56, v56, v56
  v_lshlrev_b32 v56, 16, v56
  v_fmac_f32 v30, v56, v45
  v_mul_u32_u24 v4, 1792, v1
  v_lshl_add_u32 v4, v2, 2, v4
  ds_write_b32 v4, v24 offset:56384
  ds_write_b32 v4, v25 offset:56640
  ds_write_b32 v4, v26 offset:56896
  ds_write_b32 v4, v27 offset:57152
  ds_write_b32 v4, v28 offset:57408
  ds_write_b32 v4, v29 offset:57664
  ds_write_b32 v4, v30 offset:57920
  s_waitcnt lgkmcnt(0)
  s_barrier
  s_add_u32 s60, s26, 0
  buffer_load_dwordx4 v[64:67], v3, s[12:15], s60 offen
  s_add_u32 s60, s26, 1024
  buffer_load_dwordx4 v[68:71], v3, s[12:15], s60 offen
  s_add_u32 s60, s26, 2048
  buffer_load_dwordx4 v[72:75], v3, s[12:15], s60 offen
  s_add_u32 s60, s26, 3072
  buffer_load_dwordx4 v[76:79], v3, s[12:15], s60 offen
  s_add_u32 s60, s26, 4096
  buffer_load_dwordx4 v[80:83], v3, s[12:15], s60 offen
  s_add_u32 s60, s26, 5120
  buffer_load_dwordx4 v[84:87], v3, s[12:15], s60 offen
  s_add_u32 s60, s26, 6144
  buffer_load_dwordx4 v[88:91], v3, s[12:15], s60 offen
  s_add_u32 s60, s26, 7168
  buffer_load_dwordx4 v[92:95], v3, s[12:15], s60 offen
  s_add_u32 s60, s26, 8192
  buffer_load_dwordx4 v[96:99], v3, s[12:15], s60 offen
  s_add_u32 s60, s26, 9216
  buffer_load_dwordx4 v[100:103], v3, s[12:15], s60 offen
  s_add_u32 s60, s26, 10240
  buffer_load_dwordx4 v[104:107], v3, s[12:15], s60 offen
  s_add_u32 s60, s26, 11264
  buffer_load_dwordx4 v[108:111], v3, s[12:15], s60 offen
  s_add_u32 s60, s26, 12288
  buffer_load_dwordx4 v[112:115], v3, s[12:15], s60 offen
  s_add_u32 s60, s26, 13312
  buffer_load_dwordx4 v[116:119], v3, s[12:15], s60 offen
  s_add_u32 s60, s26, 14336
  buffer_load_dwordx4 v[120:123], v3, s[12:15], s60 offen
  s_add_u32 s60, s26, 15360
  buffer_load_dwordx4 v[124:127], v3, s[12:15], s60 offen
  s_add_u32 s60, s26, 0
  buffer_load_dwordx4 v[128:131], v3, s[16:19], s60 offen
  s_add_u32 s60, s26, 1024
  buffer_load_dwordx4 v[132:135], v3, s[16:19], s60 offen
  s_add_u32 s60, s26, 2048
  buffer_load_dwordx4 v[136:139], v3, s[16:19], s60 offen
  s_add_u32 s60, s26, 3072
  buffer_load_dwordx4 v[140:143], v3, s[16:19], s60 offen
  s_add_u32 s60, s26, 4096
  buffer_load_dwordx4 v[144:147], v3, s[16:19], s60 offen
  s_add_u32 s60, s26, 5120
  buffer_load_dwordx4 v[148:151], v3, s[16:19], s60 offen
  s_add_u32 s60, s26, 6144
  buffer_load_dwordx4 v[152:155], v3, s[16:19], s60 offen
  s_add_u32 s60, s26, 7168
  buffer_load_dwordx4 v[156:159], v3, s[16:19], s60 offen
  s_add_u32 s60, s26, 8192
  buffer_load_dwordx4 v[160:163], v3, s[16:19], s60 offen
  s_add_u32 s60, s26, 9216
  buffer_load_dwordx4 v[164:167], v3, s[16:19], s60 offen
  s_add_u32 s60, s26, 10240
  buffer_load_dwordx4 v[168:171], v3, s[16:19], s60 offen
  s_add_u32 s60, s26, 11264
  buffer_load_dwordx4 v[172:175], v3, s[16:19], s60 offen
  s_add_u32 s60, s26, 12288
  buffer_load_dwordx4 v[176:179], v3, s[16:19], s60 offen
  s_add_u32 s60, s26, 13312
  buffer_load_dwordx4 v[180:183], v3, s[16:19], s60 offen
  s_add_u32 s60, s26, 14336
  buffer_load_dwordx4 v[184:187], v3, s[16:19], s60 offen
  s_add_u32 s60, s26, 15360
  buffer_load_dwordx4 v[188:191], v3, s[16:19], s60 offen
  v_cvt_f32_u32 v208, v0
  v_mul_f32 v208, 0.017857142857142856, v208
  v_add_f32 v208, 0x3a000000, v208
  v_cvt_u32_f32 v208, v208
  v_mul_u32_u24 v209, 56, v208
  v_sub_u32 v209, v0, v209
  s_lshl_b32 s3, s2, 4
  v_lshlrev_b32 v4, 2, v208
  v_add_u32 v4, s3, v4
  v_mul_u32_u24 v4, 896, v4
  v_lshl_add_u32 v4, v209, 4, v4
  buffer_load_dwordx4 v[192:195], v4, s[28:31], 0 offen offset:0
  buffer_load_dwordx4 v[196:199], v4, s[28:31], 0 offen offset:896
  buffer_load_dwordx4 v[200:203], v4, s[28:31], 0 offen offset:1792
  buffer_load_dwordx4 v[204:207], v4, s[28:31], 0 offen offset:2688
  s_barrier
  v_and_b32 v4, 31, v2
  v_lshlrev_b32 v4, 4, v4
  ds_read_b128 v[8:11], v4 offset:37120
  ds_read_b128 v[12:15], v4 offset:37632
  s_waitcnt vmcnt(20) lgkmcnt(0)
  v_mov_b32 v16, 0
  v_dot2_f32_bf16 v16, v64, v8, v16
  v_dot2_f32_bf16 v16, v65, v9, v16
  v_dot2_f32_bf16 v16, v66, v10, v16
  v_dot2_f32_bf16 v16, v67, v11, v16
  v_mov_b32 v32, 0
  v_dot2_f32_bf16 v32, v64, v12, v32
  v_dot2_f32_bf16 v32, v65, v13, v32
  v_dot2_f32_bf16 v32, v66, v14, v32
  v_dot2_f32_bf16 v32, v67, v15, v32
  v_mov_b32 v17, 0
  v_dot2_f32_bf16 v17, v68, v8, v17
  v_dot2_f32_bf16 v17, v69, v9, v17
  v_dot2_f32_bf16 v17, v70, v10, v17
  v_dot2_f32_bf16 v17, v71, v11, v17
  v_mov_b32 v33, 0
  v_dot2_f32_bf16 v33, v68, v12, v33
  v_dot2_f32_bf16 v33, v69, v13, v33
  v_dot2_f32_bf16 v33, v70, v14, v33
  v_dot2_f32_bf16 v33, v71, v15, v33
  v_mov_b32 v18, 0
  v_dot2_f32_bf16 v18, v72, v8, v18
  v_dot2_f32_bf16 v18, v73, v9, v18
  v_dot2_f32_bf16 v18, v74, v10, v18
  v_dot2_f32_bf16 v18, v75, v11, v18
  v_mov_b32 v34, 0
  v_dot2_f32_bf16 v34, v72, v12, v34
  v_dot2_f32_bf16 v34, v73, v13, v34
  v_dot2_f32_bf16 v34, v74, v14, v34
  v_dot2_f32_bf16 v34, v75, v15, v34
  v_mov_b32 v19, 0
  v_dot2_f32_bf16 v19, v76, v8, v19
  v_dot2_f32_bf16 v19, v77, v9, v19
  v_dot2_f32_bf16 v19, v78, v10, v19
  v_dot2_f32_bf16 v19, v79, v11, v19
  v_mov_b32 v35, 0
  v_dot2_f32_bf16 v35, v76, v12, v35
  v_dot2_f32_bf16 v35, v77, v13, v35
  v_dot2_f32_bf16 v35, v78, v14, v35
  v_dot2_f32_bf16 v35, v79, v15, v35
  v_mov_b32 v20, 0
  v_dot2_f32_bf16 v20, v80, v8, v20
  v_dot2_f32_bf16 v20, v81, v9, v20
  v_dot2_f32_bf16 v20, v82, v10, v20
  v_dot2_f32_bf16 v20, v83, v11, v20
  v_mov_b32 v36, 0
  v_dot2_f32_bf16 v36, v80, v12, v36
  v_dot2_f32_bf16 v36, v81, v13, v36
  v_dot2_f32_bf16 v36, v82, v14, v36
  v_dot2_f32_bf16 v36, v83, v15, v36
  v_mov_b32 v21, 0
  v_dot2_f32_bf16 v21, v84, v8, v21
  v_dot2_f32_bf16 v21, v85, v9, v21
  v_dot2_f32_bf16 v21, v86, v10, v21
  v_dot2_f32_bf16 v21, v87, v11, v21
  v_mov_b32 v37, 0
  v_dot2_f32_bf16 v37, v84, v12, v37
  v_dot2_f32_bf16 v37, v85, v13, v37
  v_dot2_f32_bf16 v37, v86, v14, v37
  v_dot2_f32_bf16 v37, v87, v15, v37
  v_mov_b32 v22, 0
  v_dot2_f32_bf16 v22, v88, v8, v22
  v_dot2_f32_bf16 v22, v89, v9, v22
  v_dot2_f32_bf16 v22, v90, v10, v22
  v_dot2_f32_bf16 v22, v91, v11, v22
  v_mov_b32 v38, 0
  v_dot2_f32_bf16 v38, v88, v12, v38
  v_dot2_f32_bf16 v38, v89, v13, v38
  v_dot2_f32_bf16 v38, v90, v14, v38
  v_dot2_f32_bf16 v38, v91, v15, v38
  v_mov_b32 v23, 0
  v_dot2_f32_bf16 v23, v92, v8, v23
  v_dot2_f32_bf16 v23, v93, v9, v23
  v_dot2_f32_bf16 v23, v94, v10, v23
  v_dot2_f32_bf16 v23, v95, v11, v23
  v_mov_b32 v39, 0
  v_dot2_f32_bf16 v39, v92, v12, v39
  v_dot2_f32_bf16 v39, v93, v13, v39
  v_dot2_f32_bf16 v39, v94, v14, v39
  v_dot2_f32_bf16 v39, v95, v15, v39
  v_mov_b32 v24, 0
  v_dot2_f32_bf16 v24, v96, v8, v24
  v_dot2_f32_bf16 v24, v97, v9, v24
  v_dot2_f32_bf16 v24, v98, v10, v24
  v_dot2_f32_bf16 v24, v99, v11, v24
  v_mov_b32 v40, 0
  v_dot2_f32_bf16 v40, v96, v12, v40
  v_dot2_f32_bf16 v40, v97, v13, v40
  v_dot2_f32_bf16 v40, v98, v14, v40
  v_dot2_f32_bf16 v40, v99, v15, v40
  v_mov_b32 v25, 0
  v_dot2_f32_bf16 v25, v100, v8, v25
  v_dot2_f32_bf16 v25, v101, v9, v25
  v_dot2_f32_bf16 v25, v102, v10, v25
  v_dot2_f32_bf16 v25, v103, v11, v25
  v_mov_b32 v41, 0
  v_dot2_f32_bf16 v41, v100, v12, v41
  v_dot2_f32_bf16 v41, v101, v13, v41
  v_dot2_f32_bf16 v41, v102, v14, v41
  v_dot2_f32_bf16 v41, v103, v15, v41
  v_mov_b32 v26, 0
  v_dot2_f32_bf16 v26, v104, v8, v26
  v_dot2_f32_bf16 v26, v105, v9, v26
  v_dot2_f32_bf16 v26, v106, v10, v26
  v_dot2_f32_bf16 v26, v107, v11, v26
  v_mov_b32 v42, 0
  v_dot2_f32_bf16 v42, v104, v12, v42
  v_dot2_f32_bf16 v42, v105, v13, v42
  v_dot2_f32_bf16 v42, v106, v14, v42
  v_dot2_f32_bf16 v42, v107, v15, v42
  v_mov_b32 v27, 0
  v_dot2_f32_bf16 v27, v108, v8, v27
  v_dot2_f32_bf16 v27, v109, v9, v27
  v_dot2_f32_bf16 v27, v110, v10, v27
  v_dot2_f32_bf16 v27, v111, v11, v27
  v_mov_b32 v43, 0
  v_dot2_f32_bf16 v43, v108, v12, v43
  v_dot2_f32_bf16 v43, v109, v13, v43
  v_dot2_f32_bf16 v43, v110, v14, v43
  v_dot2_f32_bf16 v43, v111, v15, v43
  v_mov_b32 v28, 0
  v_dot2_f32_bf16 v28, v112, v8, v28
  v_dot2_f32_bf16 v28, v113, v9, v28
  v_dot2_f32_bf16 v28, v114, v10, v28
  v_dot2_f32_bf16 v28, v115, v11, v28
  v_mov_b32 v44, 0
  v_dot2_f32_bf16 v44, v112, v12, v44
  v_dot2_f32_bf16 v44, v113, v13, v44
  v_dot2_f32_bf16 v44, v114, v14, v44
  v_dot2_f32_bf16 v44, v115, v15, v44
  v_mov_b32 v29, 0
  v_dot2_f32_bf16 v29, v116, v8, v29
  v_dot2_f32_bf16 v29, v117, v9, v29
  v_dot2_f32_bf16 v29, v118, v10, v29
  v_dot2_f32_bf16 v29, v119, v11, v29
  v_mov_b32 v45, 0
  v_dot2_f32_bf16 v45, v116, v12, v45
  v_dot2_f32_bf16 v45, v117, v13, v45
  v_dot2_f32_bf16 v45, v118, v14, v45
  v_dot2_f32_bf16 v45, v119, v15, v45
  v_mov_b32 v30, 0
  v_dot2_f32_bf16 v30, v120, v8, v30
  v_dot2_f32_bf16 v30, v121, v9, v30
  v_dot2_f32_bf16 v30, v122, v10, v30
  v_dot2_f32_bf16 v30, v123, v11, v30
  v_mov_b32 v46, 0
  v_dot2_f32_bf16 v46, v120, v12, v46
  v_dot2_f32_bf16 v46, v121, v13, v46
  v_dot2_f32_bf16 v46, v122, v14, v46
  v_dot2_f32_bf16 v46, v123, v15, v46
  v_mov_b32 v31, 0
  v_dot2_f32_bf16 v31, v124, v8, v31
  v_dot2_f32_bf16 v31, v125, v9, v31
  v_dot2_f32_bf16 v31, v126, v10, v31
  v_dot2_f32_bf16 v31, v127, v11, v31
  v_mov_b32 v47, 0
  v_dot2_f32_bf16 v47, v124, v12, v47
  v_dot2_f32_bf16 v47, v125, v13, v47
  v_dot2_f32_bf16 v47, v126, v14, v47
  v_dot2_f32_bf16 v47, v127, v15, v47
  v_mul_u32_u24 v5, 9216, v1
  v_mul_u32_u24 v6, 144, v2
  v_add_u32 v6, v5, v6
  s_nop 2
  ds_write_b128 v6, v[16:19] offset:0
  ds_write_b128 v6, v[20:23] offset:16
  ds_write_b128 v6, v[24:27] offset:32
  ds_write_b128 v6, v[28:31] offset:48
  ds_write_b128 v6, v[32:35] offset:64
  ds_write_b128 v6, v[36:39] offset:80
  ds_write_b128 v6, v[40:43] offset:96
  ds_write_b128 v6, v[44:47] offset:112
  s_waitcnt lgkmcnt(0)
  v_lshrrev_b32 v7, 5, v2
  v_mul_u32_u24 v7, 4608, v7
  v_and_b32 v6, 31, v2
  v_lshl_add_u32 v6, v6, 2, v7
  v_add_u32 v6, v5, v6
  ds_read_b32 v16, v6 offset:0
  ds_read_b32 v17, v6 offset:144
  ds_read_b32 v18, v6 offset:288
  ds_read_b32 v19, v6 offset:432
  ds_read_b32 v20, v6 offset:576
  ds_read_b32 v21, v6 offset:720
  ds_read_b32 v22, v6 offset:864
  ds_read_b32 v23, v6 offset:1008
  ds_read_b32 v24, v6 offset:1152
  ds_read_b32 v25, v6 offset:1296
  ds_read_b32 v26, v6 offset:1440
  ds_read_b32 v27, v6 offset:1584
  ds_read_b32 v28, v6 offset:1728
  ds_read_b32 v29, v6 offset:1872
  ds_read_b32 v30, v6 offset:2016
  ds_read_b32 v31, v6 offset:2160
  ds_read_b32 v32, v6 offset:2304
  ds_read_b32 v33, v6 offset:2448
  ds_read_b32 v34, v6 offset:2592
  ds_read_b32 v35, v6 offset:2736
  ds_read_b32 v36, v6 offset:2880
  ds_read_b32 v37, v6 offset:3024
  ds_read_b32 v38, v6 offset:3168
  ds_read_b32 v39, v6 offset:3312
  ds_read_b32 v40, v6 offset:3456
  ds_read_b32 v41, v6 offset:3600
  ds_read_b32 v42, v6 offset:3744
  ds_read_b32 v43, v6 offset:3888
  ds_read_b32 v44, v6 offset:4032
  ds_read_b32 v45, v6 offset:4176
  ds_read_b32 v46, v6 offset:4320
  ds_read_b32 v47, v6 offset:4464
  s_waitcnt lgkmcnt(0)
  v_add_f32 v16, v16, v17
  v_add_f32 v16, v16, v18
  v_add_f32 v16, v16, v19
  v_add_f32 v16, v16, v20
  v_add_f32 v16, v16, v21
  v_add_f32 v16, v16, v22
  v_add_f32 v16, v16, v23
  v_add_f32 v16, v16, v24
  v_add_f32 v16, v16, v25
  v_add_f32 v16, v16, v26
  v_add_f32 v16, v16, v27
  v_add_f32 v16, v16, v28
  v_add_f32 v16, v16, v29
  v_add_f32 v16, v16, v30
  v_add_f32 v16, v16, v31
  v_add_f32 v16, v16, v32
  v_add_f32 v16, v16, v33
  v_add_f32 v16, v16, v34
  v_add_f32 v16, v16, v35
  v_add_f32 v16, v16, v36
  v_add_f32 v16, v16, v37
  v_add_f32 v16, v16, v38
  v_add_f32 v16, v16, v39
  v_add_f32 v16, v16, v40
  v_add_f32 v16, v16, v41
  v_add_f32 v16, v16, v42
  v_add_f32 v16, v16, v43
  v_add_f32 v16, v16, v44
  v_add_f32 v16, v16, v45
  v_add_f32 v16, v16, v46
  v_add_f32 v16, v16, v47
  v_mul_f32 v16, 0.09016844005556021, v16
  v_mov_b32 v17, v16
  s_nop 1
  v_max_f32 v17, v17, v17 quad_perm:[1,0,3,2] row_mask:0xf bank_mask:0xf
  s_nop 1
  v_max_f32 v17, v17, v17 quad_perm:[2,3,0,1] row_mask:0xf bank_mask:0xf
  s_nop 1
  v_max_f32 v17, v17, v17 row_ror:4 row_mask:0xf bank_mask:0xf
  s_nop 1
  v_max_f32 v17, v17, v17 row_ror:8 row_mask:0xf bank_mask:0xf
  s_nop 1
  v_readlane_b32 s56, v17, 0
  v_readlane_b32 s57, v17, 16
  v_readlane_b32 s58, v17, 32
  v_readlane_b32 s59, v17, 48
  s_nop 1
  v_mov_b32 v18, s56
  v_max_f32 v18, s58, v18
  v_mov_b32 v19, s57
  v_max_f32 v19, s59, v19
  v_lshlrev_b32 v6, 3, v1
  ds_write_b64 v6, v[18:19] offset:36864
  s_waitcnt lgkmcnt(0)
  s_barrier
  v_mov_b32 v6, 0
  ds_read_b128 v[20:23], v6 offset:36864
  ds_read_b128 v[24:27], v6 offset:36880
  s_waitcnt lgkmcnt(0)
  v_max_f32 v18, v20, v22
  v_max_f32 v18, v18, v24
  v_max_f32 v8, v18, v26
  v_max_f32 v19, v21, v23
  v_max_f32 v19, v19, v25
  v_max_f32 v9, v19, v27
  v_and_b32 v6, 16, v2
  v_cmp_eq_u32 vcc, 0, v6
  s_nop 1
  v_cndmask_b32 v17, v9, v8, vcc
  v_sub_f32 v16, v16, v17
  v_exp_f32 v16, v16
  s_nop 0
  v_mov_b32 v17, v16
  s_nop 1
  v_add_f32 v17, v17, v17 quad_perm:[1,0,3,2] row_mask:0xf bank_mask:0xf
  s_nop 1
  v_add_f32 v17, v17, v17 quad_perm:[2,3,0,1] row_mask:0xf bank_mask:0xf
  s_nop 1
  v_add_f32 v17, v17, v17 row_ror:4 row_mask:0xf bank_mask:0xf
  s_nop 1
  v_add_f32 v17, v17, v17 row_ror:8 row_mask:0xf bank_mask:0xf
  s_nop 1
  v_readlane_b32 s56, v17, 0
  v_readlane_b32 s57, v17, 16
  v_readlane_b32 s58, v17, 32
  v_readlane_b32 s59, v17, 48
  s_nop 1
  v_mov_b32 v20, s56
  v_add_f32 v20, s58, v20
  v_mov_b32 v21, s57
  v_add_f32 v21, s59, v21
  v_lshlrev_b32 v6, 3, v1
  ds_write_b64 v6, v[20:21] offset:36928
  v_lshl_add_u32 v6, v2, 2, v5
  ds_write_b32 v6, v16
  s_waitcnt lgkmcnt(0)
  v_lshrrev_b32 v7, 5, v2
  v_lshl_add_u32 v6, v7, 7, v5
  ds_read_b128 v[16:19], v6 offset:0
  ds_read_b128 v[20:23], v6 offset:16
  ds_read_b128 v[24:27], v6 offset:32
  ds_read_b128 v[28:31], v6 offset:48
  ds_read_b128 v[32:35], v6 offset:64
  ds_read_b128 v[36:39], v6 offset:80
  ds_read_b128 v[40:43], v6 offset:96
  ds_read_b128 v[44:47], v6 offset:112
  v_mov_b32 v48, 0
  v_mov_b32 v49, 0
  v_mov_b32 v50, 0
  v_mov_b32 v51, 0
  v_mov_b32 v52, 0
  v_mov_b32 v53, 0
  v_mov_b32 v54, 0
  v_mov_b32 v55, 0
  v_mov_b32 v56, 0
  v_mov_b32 v57, 0
  v_mov_b32 v58, 0
  v_mov_b32 v59, 0
  v_mov_b32 v60, 0
  v_mov_b32 v61, 0
  v_mov_b32 v62, 0
  v_mov_b32 v63, 0
  s_waitcnt vmcnt(4) lgkmcnt(0)
  v_lshlrev_b32 v6, 16, v128
  v_and_b32 v7, 0xffff0000, v128
  v_fmac_f32 v48, v16, v6
  v_fmac_f32 v49, v16, v7
  v_fmac_f32 v56, v32, v6
  v_fmac_f32 v57, v32, v7
  v_lshlrev_b32 v6, 16, v129
  v_and_b32 v7, 0xffff0000, v129
  v_fmac_f32 v50, v16, v6
  v_fmac_f32 v51, v16, v7
  v_fmac_f32 v58, v32, v6
  v_fmac_f32 v59, v32, v7
  v_lshlrev_b32 v6, 16, v130
  v_and_b32 v7, 0xffff0000, v130
  v_fmac_f32 v52, v16, v6
  v_fmac_f32 v53, v16, v7
  v_fmac_f32 v60, v32, v6
  v_fmac_f32 v61, v32, v7
  v_lshlrev_b32 v6, 16, v131
  v_and_b32 v7, 0xffff0000, v131
  v_fmac_f32 v54, v16, v6
  v_fmac_f32 v55, v16, v7
  v_fmac_f32 v62, v32, v6
  v_fmac_f32 v63, v32, v7
  v_lshlrev_b32 v6, 16, v132
  v_and_b32 v7, 0xffff0000, v132
  v_fmac_f32 v48, v17, v6
  v_fmac_f32 v49, v17, v7
  v_fmac_f32 v56, v33, v6
  v_fmac_f32 v57, v33, v7
  v_lshlrev_b32 v6, 16, v133
  v_and_b32 v7, 0xffff0000, v133
  v_fmac_f32 v50, v17, v6
  v_fmac_f32 v51, v17, v7
  v_fmac_f32 v58, v33, v6
  v_fmac_f32 v59, v33, v7
  v_lshlrev_b32 v6, 16, v134
  v_and_b32 v7, 0xffff0000, v134
  v_fmac_f32 v52, v17, v6
  v_fmac_f32 v53, v17, v7
  v_fmac_f32 v60, v33, v6
  v_fmac_f32 v61, v33, v7
  v_lshlrev_b32 v6, 16, v135
  v_and_b32 v7, 0xffff0000, v135
  v_fmac_f32 v54, v17, v6
  v_fmac_f32 v55, v17, v7
  v_fmac_f32 v62, v33, v6
  v_fmac_f32 v63, v33, v7
  v_lshlrev_b32 v6, 16, v136
  v_and_b32 v7, 0xffff0000, v136
  v_fmac_f32 v48, v18, v6
  v_fmac_f32 v49, v18, v7
  v_fmac_f32 v56, v34, v6
  v_fmac_f32 v57, v34, v7
  v_lshlrev_b32 v6, 16, v137
  v_and_b32 v7, 0xffff0000, v137
  v_fmac_f32 v50, v18, v6
  v_fmac_f32 v51, v18, v7
  v_fmac_f32 v58, v34, v6
  v_fmac_f32 v59, v34, v7
  v_lshlrev_b32 v6, 16, v138
  v_and_b32 v7, 0xffff0000, v138
  v_fmac_f32 v52, v18, v6
  v_fmac_f32 v53, v18, v7
  v_fmac_f32 v60, v34, v6
  v_fmac_f32 v61, v34, v7
  v_lshlrev_b32 v6, 16, v139
  v_and_b32 v7, 0xffff0000, v139
  v_fmac_f32 v54, v18, v6
  v_fmac_f32 v55, v18, v7
  v_fmac_f32 v62, v34, v6
  v_fmac_f32 v63, v34, v7
  v_lshlrev_b32 v6, 16, v140
  v_and_b32 v7, 0xffff0000, v140
  v_fmac_f32 v48, v19, v6
  v_fmac_f32 v49, v19, v7
  v_fmac_f32 v56, v35, v6
  v_fmac_f32 v57, v35, v7
  v_lshlrev_b32 v6, 16, v141
  v_and_b32 v7, 0xffff0000, v141
  v_fmac_f32 v50, v19, v6
  v_fmac_f32 v51, v19, v7
  v_fmac_f32 v58, v35, v6
  v_fmac_f32 v59, v35, v7
  v_lshlrev_b32 v6, 16, v142
  v_and_b32 v7, 0xffff0000, v142
  v_fmac_f32 v52, v19, v6
  v_fmac_f32 v53, v19, v7
  v_fmac_f32 v60, v35, v6
  v_fmac_f32 v61, v35, v7
  v_lshlrev_b32 v6, 16, v143
  v_and_b32 v7, 0xffff0000, v143
  v_fmac_f32 v54, v19, v6
  v_fmac_f32 v55, v19, v7
  v_fmac_f32 v62, v35, v6
  v_fmac_f32 v63, v35, v7
  v_lshlrev_b32 v6, 16, v144
  v_and_b32 v7, 0xffff0000, v144
  v_fmac_f32 v48, v20, v6
  v_fmac_f32 v49, v20, v7
  v_fmac_f32 v56, v36, v6
  v_fmac_f32 v57, v36, v7
  v_lshlrev_b32 v6, 16, v145
  v_and_b32 v7, 0xffff0000, v145
  v_fmac_f32 v50, v20, v6
  v_fmac_f32 v51, v20, v7
  v_fmac_f32 v58, v36, v6
  v_fmac_f32 v59, v36, v7
  v_lshlrev_b32 v6, 16, v146
  v_and_b32 v7, 0xffff0000, v146
  v_fmac_f32 v52, v20, v6
  v_fmac_f32 v53, v20, v7
  v_fmac_f32 v60, v36, v6
  v_fmac_f32 v61, v36, v7
  v_lshlrev_b32 v6, 16, v147
  v_and_b32 v7, 0xffff0000, v147
  v_fmac_f32 v54, v20, v6
  v_fmac_f32 v55, v20, v7
  v_fmac_f32 v62, v36, v6
  v_fmac_f32 v63, v36, v7
  v_lshlrev_b32 v6, 16, v148
  v_and_b32 v7, 0xffff0000, v148
  v_fmac_f32 v48, v21, v6
  v_fmac_f32 v49, v21, v7
  v_fmac_f32 v56, v37, v6
  v_fmac_f32 v57, v37, v7
  v_lshlrev_b32 v6, 16, v149
  v_and_b32 v7, 0xffff0000, v149
  v_fmac_f32 v50, v21, v6
  v_fmac_f32 v51, v21, v7
  v_fmac_f32 v58, v37, v6
  v_fmac_f32 v59, v37, v7
  v_lshlrev_b32 v6, 16, v150
  v_and_b32 v7, 0xffff0000, v150
  v_fmac_f32 v52, v21, v6
  v_fmac_f32 v53, v21, v7
  v_fmac_f32 v60, v37, v6
  v_fmac_f32 v61, v37, v7
  v_lshlrev_b32 v6, 16, v151
  v_and_b32 v7, 0xffff0000, v151
  v_fmac_f32 v54, v21, v6
  v_fmac_f32 v55, v21, v7
  v_fmac_f32 v62, v37, v6
  v_fmac_f32 v63, v37, v7
  v_lshlrev_b32 v6, 16, v152
  v_and_b32 v7, 0xffff0000, v152
  v_fmac_f32 v48, v22, v6
  v_fmac_f32 v49, v22, v7
  v_fmac_f32 v56, v38, v6
  v_fmac_f32 v57, v38, v7
  v_lshlrev_b32 v6, 16, v153
  v_and_b32 v7, 0xffff0000, v153
  v_fmac_f32 v50, v22, v6
  v_fmac_f32 v51, v22, v7
  v_fmac_f32 v58, v38, v6
  v_fmac_f32 v59, v38, v7
  v_lshlrev_b32 v6, 16, v154
  v_and_b32 v7, 0xffff0000, v154
  v_fmac_f32 v52, v22, v6
  v_fmac_f32 v53, v22, v7
  v_fmac_f32 v60, v38, v6
  v_fmac_f32 v61, v38, v7
  v_lshlrev_b32 v6, 16, v155
  v_and_b32 v7, 0xffff0000, v155
  v_fmac_f32 v54, v22, v6
  v_fmac_f32 v55, v22, v7
  v_fmac_f32 v62, v38, v6
  v_fmac_f32 v63, v38, v7
  v_lshlrev_b32 v6, 16, v156
  v_and_b32 v7, 0xffff0000, v156
  v_fmac_f32 v48, v23, v6
  v_fmac_f32 v49, v23, v7
  v_fmac_f32 v56, v39, v6
  v_fmac_f32 v57, v39, v7
  v_lshlrev_b32 v6, 16, v157
  v_and_b32 v7, 0xffff0000, v157
  v_fmac_f32 v50, v23, v6
  v_fmac_f32 v51, v23, v7
  v_fmac_f32 v58, v39, v6
  v_fmac_f32 v59, v39, v7
  v_lshlrev_b32 v6, 16, v158
  v_and_b32 v7, 0xffff0000, v158
  v_fmac_f32 v52, v23, v6
  v_fmac_f32 v53, v23, v7
  v_fmac_f32 v60, v39, v6
  v_fmac_f32 v61, v39, v7
  v_lshlrev_b32 v6, 16, v159
  v_and_b32 v7, 0xffff0000, v159
  v_fmac_f32 v54, v23, v6
  v_fmac_f32 v55, v23, v7
  v_fmac_f32 v62, v39, v6
  v_fmac_f32 v63, v39, v7
  v_lshlrev_b32 v6, 16, v160
  v_and_b32 v7, 0xffff0000, v160
  v_fmac_f32 v48, v24, v6
  v_fmac_f32 v49, v24, v7
  v_fmac_f32 v56, v40, v6
  v_fmac_f32 v57, v40, v7
  v_lshlrev_b32 v6, 16, v161
  v_and_b32 v7, 0xffff0000, v161
  v_fmac_f32 v50, v24, v6
  v_fmac_f32 v51, v24, v7
  v_fmac_f32 v58, v40, v6
  v_fmac_f32 v59, v40, v7
  v_lshlrev_b32 v6, 16, v162
  v_and_b32 v7, 0xffff0000, v162
  v_fmac_f32 v52, v24, v6
  v_fmac_f32 v53, v24, v7
  v_fmac_f32 v60, v40, v6
  v_fmac_f32 v61, v40, v7
  v_lshlrev_b32 v6, 16, v163
  v_and_b32 v7, 0xffff0000, v163
  v_fmac_f32 v54, v24, v6
  v_fmac_f32 v55, v24, v7
  v_fmac_f32 v62, v40, v6
  v_fmac_f32 v63, v40, v7
  v_lshlrev_b32 v6, 16, v164
  v_and_b32 v7, 0xffff0000, v164
  v_fmac_f32 v48, v25, v6
  v_fmac_f32 v49, v25, v7
  v_fmac_f32 v56, v41, v6
  v_fmac_f32 v57, v41, v7
  v_lshlrev_b32 v6, 16, v165
  v_and_b32 v7, 0xffff0000, v165
  v_fmac_f32 v50, v25, v6
  v_fmac_f32 v51, v25, v7
  v_fmac_f32 v58, v41, v6
  v_fmac_f32 v59, v41, v7
  v_lshlrev_b32 v6, 16, v166
  v_and_b32 v7, 0xffff0000, v166
  v_fmac_f32 v52, v25, v6
  v_fmac_f32 v53, v25, v7
  v_fmac_f32 v60, v41, v6
  v_fmac_f32 v61, v41, v7
  v_lshlrev_b32 v6, 16, v167
  v_and_b32 v7, 0xffff0000, v167
  v_fmac_f32 v54, v25, v6
  v_fmac_f32 v55, v25, v7
  v_fmac_f32 v62, v41, v6
  v_fmac_f32 v63, v41, v7
  v_lshlrev_b32 v6, 16, v168
  v_and_b32 v7, 0xffff0000, v168
  v_fmac_f32 v48, v26, v6
  v_fmac_f32 v49, v26, v7
  v_fmac_f32 v56, v42, v6
  v_fmac_f32 v57, v42, v7
  v_lshlrev_b32 v6, 16, v169
  v_and_b32 v7, 0xffff0000, v169
  v_fmac_f32 v50, v26, v6
  v_fmac_f32 v51, v26, v7
  v_fmac_f32 v58, v42, v6
  v_fmac_f32 v59, v42, v7
  v_lshlrev_b32 v6, 16, v170
  v_and_b32 v7, 0xffff0000, v170
  v_fmac_f32 v52, v26, v6
  v_fmac_f32 v53, v26, v7
  v_fmac_f32 v60, v42, v6
  v_fmac_f32 v61, v42, v7
  v_lshlrev_b32 v6, 16, v171
  v_and_b32 v7, 0xffff0000, v171
  v_fmac_f32 v54, v26, v6
  v_fmac_f32 v55, v26, v7
  v_fmac_f32 v62, v42, v6
  v_fmac_f32 v63, v42, v7
  v_lshlrev_b32 v6, 16, v172
  v_and_b32 v7, 0xffff0000, v172
  v_fmac_f32 v48, v27, v6
  v_fmac_f32 v49, v27, v7
  v_fmac_f32 v56, v43, v6
  v_fmac_f32 v57, v43, v7
  v_lshlrev_b32 v6, 16, v173
  v_and_b32 v7, 0xffff0000, v173
  v_fmac_f32 v50, v27, v6
  v_fmac_f32 v51, v27, v7
  v_fmac_f32 v58, v43, v6
  v_fmac_f32 v59, v43, v7
  v_lshlrev_b32 v6, 16, v174
  v_and_b32 v7, 0xffff0000, v174
  v_fmac_f32 v52, v27, v6
  v_fmac_f32 v53, v27, v7
  v_fmac_f32 v60, v43, v6
  v_fmac_f32 v61, v43, v7
  v_lshlrev_b32 v6, 16, v175
  v_and_b32 v7, 0xffff0000, v175
  v_fmac_f32 v54, v27, v6
  v_fmac_f32 v55, v27, v7
  v_fmac_f32 v62, v43, v6
  v_fmac_f32 v63, v43, v7
  v_lshlrev_b32 v6, 16, v176
  v_and_b32 v7, 0xffff0000, v176
  v_fmac_f32 v48, v28, v6
  v_fmac_f32 v49, v28, v7
  v_fmac_f32 v56, v44, v6
  v_fmac_f32 v57, v44, v7
  v_lshlrev_b32 v6, 16, v177
  v_and_b32 v7, 0xffff0000, v177
  v_fmac_f32 v50, v28, v6
  v_fmac_f32 v51, v28, v7
  v_fmac_f32 v58, v44, v6
  v_fmac_f32 v59, v44, v7
  v_lshlrev_b32 v6, 16, v178
  v_and_b32 v7, 0xffff0000, v178
  v_fmac_f32 v52, v28, v6
  v_fmac_f32 v53, v28, v7
  v_fmac_f32 v60, v44, v6
  v_fmac_f32 v61, v44, v7
  v_lshlrev_b32 v6, 16, v179
  v_and_b32 v7, 0xffff0000, v179
  v_fmac_f32 v54, v28, v6
  v_fmac_f32 v55, v28, v7
  v_fmac_f32 v62, v44, v6
  v_fmac_f32 v63, v44, v7
  v_lshlrev_b32 v6, 16, v180
  v_and_b32 v7, 0xffff0000, v180
  v_fmac_f32 v48, v29, v6
  v_fmac_f32 v49, v29, v7
  v_fmac_f32 v56, v45, v6
  v_fmac_f32 v57, v45, v7
  v_lshlrev_b32 v6, 16, v181
  v_and_b32 v7, 0xffff0000, v181
  v_fmac_f32 v50, v29, v6
  v_fmac_f32 v51, v29, v7
  v_fmac_f32 v58, v45, v6
  v_fmac_f32 v59, v45, v7
  v_lshlrev_b32 v6, 16, v182
  v_and_b32 v7, 0xffff0000, v182
  v_fmac_f32 v52, v29, v6
  v_fmac_f32 v53, v29, v7
  v_fmac_f32 v60, v45, v6
  v_fmac_f32 v61, v45, v7
  v_lshlrev_b32 v6, 16, v183
  v_and_b32 v7, 0xffff0000, v183
  v_fmac_f32 v54, v29, v6
  v_fmac_f32 v55, v29, v7
  v_fmac_f32 v62, v45, v6
  v_fmac_f32 v63, v45, v7
  v_lshlrev_b32 v6, 16, v184
  v_and_b32 v7, 0xffff0000, v184
  v_fmac_f32 v48, v30, v6
  v_fmac_f32 v49, v30, v7
  v_fmac_f32 v56, v46, v6
  v_fmac_f32 v57, v46, v7
  v_lshlrev_b32 v6, 16, v185
  v_and_b32 v7, 0xffff0000, v185
  v_fmac_f32 v50, v30, v6
  v_fmac_f32 v51, v30, v7
  v_fmac_f32 v58, v46, v6
  v_fmac_f32 v59, v46, v7
  v_lshlrev_b32 v6, 16, v186
  v_and_b32 v7, 0xffff0000, v186
  v_fmac_f32 v52, v30, v6
  v_fmac_f32 v53, v30, v7
  v_fmac_f32 v60, v46, v6
  v_fmac_f32 v61, v46, v7
  v_lshlrev_b32 v6, 16, v187
  v_and_b32 v7, 0xffff0000, v187
  v_fmac_f32 v54, v30, v6
  v_fmac_f32 v55, v30, v7
  v_fmac_f32 v62, v46, v6
  v_fmac_f32 v63, v46, v7
  v_lshlrev_b32 v6, 16, v188
  v_and_b32 v7, 0xffff0000, v188
  v_fmac_f32 v48, v31, v6
  v_fmac_f32 v49, v31, v7
  v_fmac_f32 v56, v47, v6
  v_fmac_f32 v57, v47, v7
  v_lshlrev_b32 v6, 16, v189
  v_and_b32 v7, 0xffff0000, v189
  v_fmac_f32 v50, v31, v6
  v_fmac_f32 v51, v31, v7
  v_fmac_f32 v58, v47, v6
  v_fmac_f32 v59, v47, v7
  v_lshlrev_b32 v6, 16, v190
  v_and_b32 v7, 0xffff0000, v190
  v_fmac_f32 v52, v31, v6
  v_fmac_f32 v53, v31, v7
  v_fmac_f32 v60, v47, v6
  v_fmac_f32 v61, v47, v7
  v_lshlrev_b32 v6, 16, v191
  v_and_b32 v7, 0xffff0000, v191
  v_fmac_f32 v54, v31, v6
  v_fmac_f32 v55, v31, v7
  v_fmac_f32 v62, v47, v6
  v_fmac_f32 v63, v47, v7
  s_barrier
  v_lshrrev_b32 v7, 5, v0
  v_lshlrev_b32 v7, 11, v7
  v_and_b32 v6, 31, v2
  v_lshl_add_u32 v6, v6, 5, v7
  ds_write_b128 v6, v[48:51] offset:0
  ds_write_b128 v6, v[52:55] offset:16
  ds_write_b128 v6, v[56:59] offset:1024
  ds_write_b128 v6, v[60:63] offset:1040
  s_waitcnt lgkmcnt(0)
  s_barrier
  v_lshlrev_b32 v6, 2, v0
  ds_read_b32 v16, v6 offset:0
  ds_read_b32 v17, v6 offset:2048
  ds_read_b32 v18, v6 offset:4096
  ds_read_b32 v19, v6 offset:6144
  ds_read_b32 v20, v6 offset:8192
  ds_read_b32 v21, v6 offset:10240
  ds_read_b32 v22, v6 offset:12288
  ds_read_b32 v23, v6 offset:14336
  ds_read_b32 v24, v6 offset:1024
  ds_read_b32 v25, v6 offset:3072
  ds_read_b32 v26, v6 offset:5120
  ds_read_b32 v27, v6 offset:7168
  ds_read_b32 v28, v6 offset:9216
  ds_read_b32 v29, v6 offset:11264
  ds_read_b32 v30, v6 offset:13312
  ds_read_b32 v31, v6 offset:15360
  v_mov_b32 v7, 0
  ds_read_b128 v[32:35], v7 offset:36928
  ds_read_b128 v[36:39], v7 offset:36944
  s_waitcnt lgkmcnt(0)
  v_add_f32 v16, v16, v17
  v_add_f32 v16, v16, v18
  v_add_f32 v16, v16, v19
  v_add_f32 v16, v16, v20
  v_add_f32 v16, v16, v21
  v_add_f32 v16, v16, v22
  v_add_f32 v16, v16, v23
  v_add_f32 v24, v24, v25
  v_add_f32 v24, v24, v26
  v_add_f32 v24, v24, v27
  v_add_f32 v24, v24, v28
  v_add_f32 v24, v24, v29
  v_add_f32 v24, v24, v30
  v_add_f32 v24, v24, v31
  v_add_f32 v32, v32, v34
  v_add_f32 v32, v32, v36
  v_add_f32 v32, v32, v38
  v_add_f32 v33, v33, v35
  v_add_f32 v33, v33, v37
  v_add_f32 v33, v33, v39
  s_lshl_b32 s27, s90, 16
  s_lshl_b32 s61, s91, 10
  s_add_u32 s27, s27, s61
  s_add_u32 s27, s27, 65536
  s_add_u32 s61, s27, 32768
  buffer_store_dword v16, v6, s[20:23], s27 offen sc0 sc1
  buffer_store_dword v24, v6, s[20:23], s61 offen sc0 sc1
  v_readfirstlane_b32 s3, v1
  s_cmp_lg_u32 s3, 0
  s_cbranch_scc1 SKIP_ML
  s_lshl_b32 s27, s90, 8
  s_lshl_b32 s61, s91, 2
  s_add_u32 s27, s27, s61
  s_add_u32 s61, s27, 1048576
  v_mov_b32 v6, 0
  buffer_store_dword v8, v6, s[20:23], s61 offen sc0 sc1
  buffer_store_dword v9, v6, s[20:23], s61 offen offset:128 sc0 sc1
  s_add_u32 s61, s27, 1052672
  buffer_store_dword v32, v6, s[20:23], s61 offen sc0 sc1
  buffer_store_dword v33, v6, s[20:23], s61 offen offset:128 sc0 sc1
SKIP_ML:
  s_waitcnt vmcnt(0)
  s_barrier
  s_cmp_lg_u32 s3, 0
  s_cbranch_scc1 SKIP_SYNC2
  v_mov_b32 v6, 0
P_RST:
  buffer_load_dword v10, v6, s[40:43], 64 offen sc0 sc1
  s_waitcnt vmcnt(0)
  v_readfirstlane_b32 s60, v10
  s_cmp_ge_u32 s60, 1
  s_cbranch_scc1 P_RST_D
  s_sleep 2
  s_branch P_RST
P_RST_D:
  s_lshl_b32 s61, s90, 8
  s_add_u32 s61, s61, 2097152
  v_mov_b32 v11, 1
  s_mov_b64 exec, 1
  buffer_atomic_add v11, v6, s[20:23], s61 offen sc1
  s_mov_b64 exec, -1
P_G2:
  buffer_load_dword v10, v6, s[20:23], s61 offen sc0 sc1
  s_waitcnt vmcnt(0)
  v_readfirstlane_b32 s60, v10
  s_cmp_ge_u32 s60, 32
  s_cbranch_scc1 P_G2_D
  s_sleep 2
  s_branch P_G2
P_G2_D:
SKIP_SYNC2:
  s_barrier
  s_lshr_b32 s62, s2, 4
  s_and_b32 s63, s2, 15
  s_lshl_b32 s63, s63, 6
  s_lshl_b32 s26, s62, 7
  s_add_u32 s27, s26, 1048576
  s_add_u32 s61, s26, 1052672
  v_mov_b32 v4, 0
  buffer_load_dwordx4 v[96:99], v4, s[20:23], s27 offen offset:0 sc0 sc1
  buffer_load_dwordx4 v[100:103], v4, s[20:23], s27 offen offset:16 sc0 sc1
  buffer_load_dwordx4 v[104:107], v4, s[20:23], s27 offen offset:32 sc0 sc1
  buffer_load_dwordx4 v[108:111], v4, s[20:23], s27 offen offset:48 sc0 sc1
  buffer_load_dwordx4 v[112:115], v4, s[20:23], s27 offen offset:64 sc0 sc1
  buffer_load_dwordx4 v[116:119], v4, s[20:23], s27 offen offset:80 sc0 sc1
  buffer_load_dwordx4 v[120:123], v4, s[20:23], s27 offen offset:96 sc0 sc1
  buffer_load_dwordx4 v[124:127], v4, s[20:23], s27 offen offset:112 sc0 sc1
  buffer_load_dwordx4 v[128:131], v4, s[20:23], s61 offen offset:0 sc0 sc1
  buffer_load_dwordx4 v[132:135], v4, s[20:23], s61 offen offset:16 sc0 sc1
  buffer_load_dwordx4 v[136:139], v4, s[20:23], s61 offen offset:32 sc0 sc1
  buffer_load_dwordx4 v[140:143], v4, s[20:23], s61 offen offset:48 sc0 sc1
  buffer_load_dwordx4 v[144:147], v4, s[20:23], s61 offen offset:64 sc0 sc1
  buffer_load_dwordx4 v[148:151], v4, s[20:23], s61 offen offset:80 sc0 sc1
  buffer_load_dwordx4 v[152:155], v4, s[20:23], s61 offen offset:96 sc0 sc1
  buffer_load_dwordx4 v[156:159], v4, s[20:23], s61 offen offset:112 sc0 sc1
  v_lshrrev_b32 v5, 4, v0
  v_lshlrev_b32 v5, 10, v5
  v_and_b32 v6, 15, v0
  v_lshl_add_u32 v5, v6, 2, v5
  s_lshl_b32 s26, s62, 15
  s_add_u32 s26, s26, s63
  s_add_u32 s26, s26, 65536
  s_add_u32 s60, s26, 16384
  buffer_load_dword v8, v5, s[20:23], s26 offen sc0 sc1
  buffer_load_dword v9, v5, s[20:23], s60 offen sc0 sc1
  v_lshrrev_b32 v5, 4, v0
  v_lshlrev_b32 v5, 2, v5
  buffer_load_dword v22, v5, s[20:23], s27 offen sc0 sc1
  buffer_load_dword v23, v5, s[20:23], s27 offen offset:64 sc0 sc1
  s_waitcnt vmcnt(0)
  v_max_f32 v20, v96, v97
  v_max_f32 v20, v20, v98
  v_max_f32 v20, v20, v99
  v_max_f32 v20, v20, v100
  v_max_f32 v20, v20, v101
  v_max_f32 v20, v20, v102
  v_max_f32 v20, v20, v103
  v_max_f32 v20, v20, v104
  v_max_f32 v20, v20, v105
  v_max_f32 v20, v20, v106
  v_max_f32 v20, v20, v107
  v_max_f32 v20, v20, v108
  v_max_f32 v20, v20, v109
  v_max_f32 v20, v20, v110
  v_max_f32 v20, v20, v111
  v_max_f32 v20, v20, v112
  v_max_f32 v20, v20, v113
  v_max_f32 v20, v20, v114
  v_max_f32 v20, v20, v115
  v_max_f32 v20, v20, v116
  v_max_f32 v20, v20, v117
  v_max_f32 v20, v20, v118
  v_max_f32 v20, v20, v119
  v_max_f32 v20, v20, v120
  v_max_f32 v20, v20, v121
  v_max_f32 v20, v20, v122
  v_max_f32 v20, v20, v123
  v_max_f32 v20, v20, v124
  v_max_f32 v20, v20, v125
  v_max_f32 v20, v20, v126
  v_max_f32 v20, v20, v127
  v_mov_b32 v21, 0
  v_sub_f32 v96, v96, v20
  v_exp_f32 v96, v96
  s_nop 0
  v_fmac_f32 v21, v96, v128
  v_sub_f32 v97, v97, v20
  v_exp_f32 v97, v97
  s_nop 0
  v_fmac_f32 v21, v97, v129
  v_sub_f32 v98, v98, v20
  v_exp_f32 v98, v98
  s_nop 0
  v_fmac_f32 v21, v98, v130
  v_sub_f32 v99, v99, v20
  v_exp_f32 v99, v99
  s_nop 0
  v_fmac_f32 v21, v99, v131
  v_sub_f32 v100, v100, v20
  v_exp_f32 v100, v100
  s_nop 0
  v_fmac_f32 v21, v100, v132
  v_sub_f32 v101, v101, v20
  v_exp_f32 v101, v101
  s_nop 0
  v_fmac_f32 v21, v101, v133
  v_sub_f32 v102, v102, v20
  v_exp_f32 v102, v102
  s_nop 0
  v_fmac_f32 v21, v102, v134
  v_sub_f32 v103, v103, v20
  v_exp_f32 v103, v103
  s_nop 0
  v_fmac_f32 v21, v103, v135
  v_sub_f32 v104, v104, v20
  v_exp_f32 v104, v104
  s_nop 0
  v_fmac_f32 v21, v104, v136
  v_sub_f32 v105, v105, v20
  v_exp_f32 v105, v105
  s_nop 0
  v_fmac_f32 v21, v105, v137
  v_sub_f32 v106, v106, v20
  v_exp_f32 v106, v106
  s_nop 0
  v_fmac_f32 v21, v106, v138
  v_sub_f32 v107, v107, v20
  v_exp_f32 v107, v107
  s_nop 0
  v_fmac_f32 v21, v107, v139
  v_sub_f32 v108, v108, v20
  v_exp_f32 v108, v108
  s_nop 0
  v_fmac_f32 v21, v108, v140
  v_sub_f32 v109, v109, v20
  v_exp_f32 v109, v109
  s_nop 0
  v_fmac_f32 v21, v109, v141
  v_sub_f32 v110, v110, v20
  v_exp_f32 v110, v110
  s_nop 0
  v_fmac_f32 v21, v110, v142
  v_sub_f32 v111, v111, v20
  v_exp_f32 v111, v111
  s_nop 0
  v_fmac_f32 v21, v111, v143
  v_sub_f32 v112, v112, v20
  v_exp_f32 v112, v112
  s_nop 0
  v_fmac_f32 v21, v112, v144
  v_sub_f32 v113, v113, v20
  v_exp_f32 v113, v113
  s_nop 0
  v_fmac_f32 v21, v113, v145
  v_sub_f32 v114, v114, v20
  v_exp_f32 v114, v114
  s_nop 0
  v_fmac_f32 v21, v114, v146
  v_sub_f32 v115, v115, v20
  v_exp_f32 v115, v115
  s_nop 0
  v_fmac_f32 v21, v115, v147
  v_sub_f32 v116, v116, v20
  v_exp_f32 v116, v116
  s_nop 0
  v_fmac_f32 v21, v116, v148
  v_sub_f32 v117, v117, v20
  v_exp_f32 v117, v117
  s_nop 0
  v_fmac_f32 v21, v117, v149
  v_sub_f32 v118, v118, v20
  v_exp_f32 v118, v118
  s_nop 0
  v_fmac_f32 v21, v118, v150
  v_sub_f32 v119, v119, v20
  v_exp_f32 v119, v119
  s_nop 0
  v_fmac_f32 v21, v119, v151
  v_sub_f32 v120, v120, v20
  v_exp_f32 v120, v120
  s_nop 0
  v_fmac_f32 v21, v120, v152
  v_sub_f32 v121, v121, v20
  v_exp_f32 v121, v121
  s_nop 0
  v_fmac_f32 v21, v121, v153
  v_sub_f32 v122, v122, v20
  v_exp_f32 v122, v122
  s_nop 0
  v_fmac_f32 v21, v122, v154
  v_sub_f32 v123, v123, v20
  v_exp_f32 v123, v123
  s_nop 0
  v_fmac_f32 v21, v123, v155
  v_sub_f32 v124, v124, v20
  v_exp_f32 v124, v124
  s_nop 0
  v_fmac_f32 v21, v124, v156
  v_sub_f32 v125, v125, v20
  v_exp_f32 v125, v125
  s_nop 0
  v_fmac_f32 v21, v125, v157
  v_sub_f32 v126, v126, v20
  v_exp_f32 v126, v126
  s_nop 0
  v_fmac_f32 v21, v126, v158
  v_sub_f32 v127, v127, v20
  v_exp_f32 v127, v127
  s_nop 0
  v_fmac_f32 v21, v127, v159
  v_rcp_f32 v21, v21
  v_sub_f32 v22, v22, v20
  v_exp_f32 v22, v22
  v_sub_f32 v23, v23, v20
  v_exp_f32 v23, v23
  s_nop 0
  v_mul_f32 v8, v8, v22
  v_fmac_f32 v8, v9, v23
  v_mul_f32 v8, v8, v21
  v_lshlrev_b32 v5, 2, v0
  ds_write_b32 v5, v8 offset:39936
  s_waitcnt lgkmcnt(0)
  s_barrier
  v_lshlrev_b32 v5, 4, v208
  ds_read_b128 v[96:99], v5 offset:39936
  ds_read_b128 v[100:103], v5 offset:40000
  ds_read_b128 v[104:107], v5 offset:40064
  ds_read_b128 v[108:111], v5 offset:40128
  ds_read_b128 v[112:115], v5 offset:40192
  ds_read_b128 v[116:119], v5 offset:40256
  ds_read_b128 v[120:123], v5 offset:40320
  ds_read_b128 v[124:127], v5 offset:40384
  ds_read_b128 v[128:131], v5 offset:40448
  ds_read_b128 v[132:135], v5 offset:40512
  ds_read_b128 v[136:139], v5 offset:40576
  ds_read_b128 v[140:143], v5 offset:40640
  ds_read_b128 v[144:147], v5 offset:40704
  ds_read_b128 v[148:151], v5 offset:40768
  ds_read_b128 v[152:155], v5 offset:40832
  ds_read_b128 v[156:159], v5 offset:40896
  s_waitcnt lgkmcnt(0)
  v_add_f32 v24, v96, v100
  v_add_f32 v24, v24, v104
  v_add_f32 v24, v24, v108
  v_add_f32 v24, v24, v112
  v_add_f32 v24, v24, v116
  v_add_f32 v24, v24, v120
  v_add_f32 v24, v24, v124
  v_add_f32 v24, v24, v128
  v_add_f32 v24, v24, v132
  v_add_f32 v24, v24, v136
  v_add_f32 v24, v24, v140
  v_add_f32 v24, v24, v144
  v_add_f32 v24, v24, v148
  v_add_f32 v24, v24, v152
  v_add_f32 v24, v24, v156
  v_cvt_pk_bf16_f32 v24, v24, v24
  v_lshlrev_b32 v24, 16, v24
  v_add_f32 v25, v97, v101
  v_add_f32 v25, v25, v105
  v_add_f32 v25, v25, v109
  v_add_f32 v25, v25, v113
  v_add_f32 v25, v25, v117
  v_add_f32 v25, v25, v121
  v_add_f32 v25, v25, v125
  v_add_f32 v25, v25, v129
  v_add_f32 v25, v25, v133
  v_add_f32 v25, v25, v137
  v_add_f32 v25, v25, v141
  v_add_f32 v25, v25, v145
  v_add_f32 v25, v25, v149
  v_add_f32 v25, v25, v153
  v_add_f32 v25, v25, v157
  v_cvt_pk_bf16_f32 v25, v25, v25
  v_lshlrev_b32 v25, 16, v25
  v_add_f32 v26, v98, v102
  v_add_f32 v26, v26, v106
  v_add_f32 v26, v26, v110
  v_add_f32 v26, v26, v114
  v_add_f32 v26, v26, v118
  v_add_f32 v26, v26, v122
  v_add_f32 v26, v26, v126
  v_add_f32 v26, v26, v130
  v_add_f32 v26, v26, v134
  v_add_f32 v26, v26, v138
  v_add_f32 v26, v26, v142
  v_add_f32 v26, v26, v146
  v_add_f32 v26, v26, v150
  v_add_f32 v26, v26, v154
  v_add_f32 v26, v26, v158
  v_cvt_pk_bf16_f32 v26, v26, v26
  v_lshlrev_b32 v26, 16, v26
  v_add_f32 v27, v99, v103
  v_add_f32 v27, v27, v107
  v_add_f32 v27, v27, v111
  v_add_f32 v27, v27, v115
  v_add_f32 v27, v27, v119
  v_add_f32 v27, v27, v123
  v_add_f32 v27, v27, v127
  v_add_f32 v27, v27, v131
  v_add_f32 v27, v27, v135
  v_add_f32 v27, v27, v139
  v_add_f32 v27, v27, v143
  v_add_f32 v27, v27, v147
  v_add_f32 v27, v27, v151
  v_add_f32 v27, v27, v155
  v_add_f32 v27, v27, v159
  v_cvt_pk_bf16_f32 v27, v27, v27
  v_lshlrev_b32 v27, 16, v27
  v_mov_b32 v32, 0
  v_mov_b32 v33, 0
  v_mov_b32 v34, 0
  v_mov_b32 v35, 0
  v_mov_b32 v36, 0
  v_mov_b32 v37, 0
  v_mov_b32 v38, 0
  v_mov_b32 v39, 0
  v_lshlrev_b32 v40, 16, v192
  v_and_b32 v41, 0xffff0000, v192
  v_fmac_f32 v32, v24, v40
  v_fmac_f32 v33, v24, v41
  v_lshlrev_b32 v40, 16, v193
  v_and_b32 v41, 0xffff0000, v193
  v_fmac_f32 v34, v24, v40
  v_fmac_f32 v35, v24, v41
  v_lshlrev_b32 v40, 16, v194
  v_and_b32 v41, 0xffff0000, v194
  v_fmac_f32 v36, v24, v40
  v_fmac_f32 v37, v24, v41
  v_lshlrev_b32 v40, 16, v195
  v_and_b32 v41, 0xffff0000, v195
  v_fmac_f32 v38, v24, v40
  v_fmac_f32 v39, v24, v41
  v_lshlrev_b32 v40, 16, v196
  v_and_b32 v41, 0xffff0000, v196
  v_fmac_f32 v32, v25, v40
  v_fmac_f32 v33, v25, v41
  v_lshlrev_b32 v40, 16, v197
  v_and_b32 v41, 0xffff0000, v197
  v_fmac_f32 v34, v25, v40
  v_fmac_f32 v35, v25, v41
  v_lshlrev_b32 v40, 16, v198
  v_and_b32 v41, 0xffff0000, v198
  v_fmac_f32 v36, v25, v40
  v_fmac_f32 v37, v25, v41
  v_lshlrev_b32 v40, 16, v199
  v_and_b32 v41, 0xffff0000, v199
  v_fmac_f32 v38, v25, v40
  v_fmac_f32 v39, v25, v41
  v_lshlrev_b32 v40, 16, v200
  v_and_b32 v41, 0xffff0000, v200
  v_fmac_f32 v32, v26, v40
  v_fmac_f32 v33, v26, v41
  v_lshlrev_b32 v40, 16, v201
  v_and_b32 v41, 0xffff0000, v201
  v_fmac_f32 v34, v26, v40
  v_fmac_f32 v35, v26, v41
  v_lshlrev_b32 v40, 16, v202
  v_and_b32 v41, 0xffff0000, v202
  v_fmac_f32 v36, v26, v40
  v_fmac_f32 v37, v26, v41
  v_lshlrev_b32 v40, 16, v203
  v_and_b32 v41, 0xffff0000, v203
  v_fmac_f32 v38, v26, v40
  v_fmac_f32 v39, v26, v41
  v_lshlrev_b32 v40, 16, v204
  v_and_b32 v41, 0xffff0000, v204
  v_fmac_f32 v32, v27, v40
  v_fmac_f32 v33, v27, v41
  v_lshlrev_b32 v40, 16, v205
  v_and_b32 v41, 0xffff0000, v205
  v_fmac_f32 v34, v27, v40
  v_fmac_f32 v35, v27, v41
  v_lshlrev_b32 v40, 16, v206
  v_and_b32 v41, 0xffff0000, v206
  v_fmac_f32 v36, v27, v40
  v_fmac_f32 v37, v27, v41
  v_lshlrev_b32 v40, 16, v207
  v_and_b32 v41, 0xffff0000, v207
  v_fmac_f32 v38, v27, v40
  v_fmac_f32 v39, v27, v41
  v_cmp_gt_u32 vcc, 224, v0
  s_and_saveexec_b64 s[92:93], vcc
  v_mul_u32_u24 v5, 1792, v208
  v_lshl_add_u32 v5, v209, 5, v5
  ds_write_b128 v5, v[32:35] offset:40960
  ds_write_b128 v5, v[36:39] offset:40976
  s_or_b64 exec, exec, s[92:93]
  s_waitcnt lgkmcnt(0)
  s_barrier
  s_and_b32 s60, s2, 15
  s_lshl_b32 s60, s60, 11
  s_add_u32 s60, s60, 2113536
  v_lshlrev_b32 v5, 2, v0
  ds_read_b32 v28, v5 offset:40960
  ds_read_b32 v29, v5 offset:42752
  ds_read_b32 v30, v5 offset:44544
  ds_read_b32 v31, v5 offset:46336
  ds_read_b32 v20, v5 offset:56384
  ds_read_b32 v21, v5 offset:58176
  ds_read_b32 v22, v5 offset:59968
  ds_read_b32 v23, v5 offset:61760
  s_waitcnt lgkmcnt(0)
  v_add_f32 v27, v20, v21
  v_add_f32 v22, v22, v23
  v_add_f32 v27, v27, v22
  v_add_f32 v28, v28, v29
  v_add_f32 v30, v30, v31
  v_add_f32 v28, v28, v30
  v_add_f32 v28, v28, v27
  buffer_atomic_add_f32 v28, v5, s[20:23], s60 offen offset:0 sc1
  v_cmp_gt_u32 vcc, 192, v0
  s_and_saveexec_b64 s[92:93], vcc
  v_lshlrev_b32 v5, 2, v0
  ds_read_b32 v28, v5 offset:41984
  ds_read_b32 v29, v5 offset:43776
  ds_read_b32 v30, v5 offset:45568
  ds_read_b32 v31, v5 offset:47360
  ds_read_b32 v20, v5 offset:57408
  ds_read_b32 v21, v5 offset:59200
  ds_read_b32 v22, v5 offset:60992
  ds_read_b32 v23, v5 offset:62784
  s_waitcnt lgkmcnt(0)
  v_add_f32 v27, v20, v21
  v_add_f32 v22, v22, v23
  v_add_f32 v27, v27, v22
  v_add_f32 v28, v28, v29
  v_add_f32 v30, v30, v31
  v_add_f32 v28, v28, v30
  v_add_f32 v28, v28, v27
  buffer_atomic_add_f32 v28, v5, s[20:23], s60 offen offset:1024 sc1
  s_or_b64 exec, exec, s[92:93]
  s_waitcnt vmcnt(0)
  s_barrier
  s_cmp_lg_u32 s3, 0
  s_cbranch_scc1 SKIP_ARR
  v_mov_b32 v6, 0
  v_mov_b32 v11, 1
  s_and_b32 s60, s2, 15
  s_lshl_b32 s60, s60, 8
  s_add_u32 s60, s60, 2101248
  s_mov_b64 exec, 1
  buffer_atomic_add v11, v6, s[20:23], s60 offen sc0 sc1
  s_mov_b64 exec, -1
  s_waitcnt vmcnt(0)
  v_readfirstlane_b32 s61, v11
  v_mov_b32 v12, 0
  s_cmp_lg_u32 s61, 15
  s_cbranch_scc1 ARR_DONE
  v_mov_b32 v11, 1
  s_mov_b32 s60, 2105344
  s_mov_b64 exec, 1
  buffer_atomic_add v11, v6, s[20:23], s60 offen sc0 sc1
  s_mov_b64 exec, -1
  s_waitcnt vmcnt(0)
  v_readfirstlane_b32 s61, v11
  s_cmp_lg_u32 s61, 15
  s_cbranch_scc1 ARR_DONE
  v_mov_b32 v12, 1
ARR_DONE:
  ds_write_b32 v6, v12 offset:48128
  s_waitcnt lgkmcnt(0)
SKIP_ARR:
  s_barrier
  v_mov_b32 v6, 0
  ds_read_b32 v12, v6 offset:48128
  s_waitcnt lgkmcnt(0)
  v_readfirstlane_b32 s61, v12
  s_cmp_eq_u32 s61, 0
  s_cbranch_scc1 END
  s_mov_b32 s12, s64
  s_and_b32 s13, s65, 0xffff
  s_mov_b32 s14, 0x380
  s_mov_b32 s15, 0x00020000
  s_mov_b32 s16, s84
  s_and_b32 s17, s85, 0xffff
  s_mov_b32 s18, 0x380
  s_mov_b32 s19, 0x00020000
  s_mov_b32 s28, s82
  s_and_b32 s29, s83, 0xffff
  s_mov_b32 s30, 0x2
  s_mov_b32 s31, 0x00020000
  v_cmp_gt_u32 vcc, 224, v0
  s_and_saveexec_b64 s[92:93], vcc
  v_lshlrev_b32 v5, 3, v0
  s_mov_b32 s60, 2113536
  buffer_load_dwordx2 v[96:97], v5, s[20:23], s60 offen sc0 sc1
  s_mov_b32 s60, 2115584
  buffer_load_dwordx2 v[98:99], v5, s[20:23], s60 offen sc0 sc1
  s_mov_b32 s60, 2117632
  buffer_load_dwordx2 v[100:101], v5, s[20:23], s60 offen sc0 sc1
  s_mov_b32 s60, 2119680
  buffer_load_dwordx2 v[102:103], v5, s[20:23], s60 offen sc0 sc1
  s_mov_b32 s60, 2121728
  buffer_load_dwordx2 v[104:105], v5, s[20:23], s60 offen sc0 sc1
  s_mov_b32 s60, 2123776
  buffer_load_dwordx2 v[106:107], v5, s[20:23], s60 offen sc0 sc1
  s_mov_b32 s60, 2125824
  buffer_load_dwordx2 v[108:109], v5, s[20:23], s60 offen sc0 sc1
  s_mov_b32 s60, 2127872
  buffer_load_dwordx2 v[110:111], v5, s[20:23], s60 offen sc0 sc1
  s_mov_b32 s60, 2129920
  buffer_load_dwordx2 v[112:113], v5, s[20:23], s60 offen sc0 sc1
  s_mov_b32 s60, 2131968
  buffer_load_dwordx2 v[114:115], v5, s[20:23], s60 offen sc0 sc1
  s_mov_b32 s60, 2134016
  buffer_load_dwordx2 v[116:117], v5, s[20:23], s60 offen sc0 sc1
  s_mov_b32 s60, 2136064
  buffer_load_dwordx2 v[118:119], v5, s[20:23], s60 offen sc0 sc1
  s_mov_b32 s60, 2138112
  buffer_load_dwordx2 v[120:121], v5, s[20:23], s60 offen sc0 sc1
  s_mov_b32 s60, 2140160
  buffer_load_dwordx2 v[122:123], v5, s[20:23], s60 offen sc0 sc1
  s_mov_b32 s60, 2142208
  buffer_load_dwordx2 v[124:125], v5, s[20:23], s60 offen sc0 sc1
  s_mov_b32 s60, 2144256
  buffer_load_dwordx2 v[126:127], v5, s[20:23], s60 offen sc0 sc1
  v_lshlrev_b32 v7, 2, v0
  buffer_load_dword v8, v7, s[12:15], 0 offen
  v_mov_b32 v6, 0
  buffer_load_ushort v9, v6, s[28:31], 0 offen
  s_waitcnt vmcnt(0)
  v_add_f32 v96, v96, v98
  v_add_f32 v97, v97, v99
  v_add_f32 v96, v96, v100
  v_add_f32 v97, v97, v101
  v_add_f32 v96, v96, v102
  v_add_f32 v97, v97, v103
  v_add_f32 v96, v96, v104
  v_add_f32 v97, v97, v105
  v_add_f32 v96, v96, v106
  v_add_f32 v97, v97, v107
  v_add_f32 v96, v96, v108
  v_add_f32 v97, v97, v109
  v_add_f32 v96, v96, v110
  v_add_f32 v97, v97, v111
  v_add_f32 v96, v96, v112
  v_add_f32 v97, v97, v113
  v_add_f32 v96, v96, v114
  v_add_f32 v97, v97, v115
  v_add_f32 v96, v96, v116
  v_add_f32 v97, v97, v117
  v_add_f32 v96, v96, v118
  v_add_f32 v97, v97, v119
  v_add_f32 v96, v96, v120
  v_add_f32 v97, v97, v121
  v_add_f32 v96, v96, v122
  v_add_f32 v97, v97, v123
  v_add_f32 v96, v96, v124
  v_add_f32 v97, v97, v125
  v_add_f32 v96, v96, v126
  v_add_f32 v97, v97, v127
  v_lshlrev_b32 v9, 16, v9
  v_lshlrev_b32 v10, 16, v8
  v_and_b32 v8, 0xffff0000, v8
  v_add_f32 v96, v96, v9
  v_add_f32 v97, v97, v9
  v_add_f32 v96, v96, v10
  v_add_f32 v97, v97, v8
  v_cvt_pk_bf16_f32 v96, v96, v97
  buffer_store_dword v96, v7, s[16:19], 0 offen
  s_waitcnt vmcnt(0)
  s_branch END
W4:
  s_mov_b32 s12, s64
  s_and_b32 s13, s65, 0xffff
  s_mov_b32 s14, 0x380
  s_mov_b32 s15, 0x00020000
  s_mov_b32 s16, s70
  s_and_b32 s17, s71, 0xffff
  s_mov_b32 s18, 0x380000
  s_mov_b32 s19, 0x00020000
  v_lshlrev_b32 v3, 1, v2
  buffer_load_ushort v10, v3, s[12:15], 0 offen offset:0
  buffer_load_ushort v11, v3, s[12:15], 0 offen offset:128
  buffer_load_ushort v12, v3, s[12:15], 0 offen offset:256
  buffer_load_ushort v13, v3, s[12:15], 0 offen offset:384
  buffer_load_ushort v14, v3, s[12:15], 0 offen offset:512
  buffer_load_ushort v15, v3, s[12:15], 0 offen offset:640
  buffer_load_ushort v16, v3, s[12:15], 0 offen offset:768
  v_lshrrev_b32 v4, 1, v2
  v_and_b32 v5, 1, v2
  v_lshlrev_b32 v6, 13, v4
  v_lshl_add_u32 v6, v5, 4, v6
  s_lshl_b32 s3, s2, 5
  v_add_u32 v6, s3, v6
  s_mov_b32 s60, 0
  buffer_load_dwordx4 v[64:67], v6, s[16:19], s60 offen
  s_mov_b32 s60, 262144
  buffer_load_dwordx4 v[68:71], v6, s[16:19], s60 offen
  s_mov_b32 s60, 524288
  buffer_load_dwordx4 v[72:75], v6, s[16:19], s60 offen
  s_mov_b32 s60, 786432
  buffer_load_dwordx4 v[76:79], v6, s[16:19], s60 offen
  s_mov_b32 s60, 1048576
  buffer_load_dwordx4 v[80:83], v6, s[16:19], s60 offen
  s_mov_b32 s60, 1310720
  buffer_load_dwordx4 v[84:87], v6, s[16:19], s60 offen
  s_mov_b32 s60, 1572864
  buffer_load_dwordx4 v[88:91], v6, s[16:19], s60 offen
  s_mov_b32 s60, 1835008
  buffer_load_dwordx4 v[92:95], v6, s[16:19], s60 offen
  s_mov_b32 s60, 2097152
  buffer_load_dwordx4 v[96:99], v6, s[16:19], s60 offen
  s_mov_b32 s60, 2359296
  buffer_load_dwordx4 v[100:103], v6, s[16:19], s60 offen
  s_mov_b32 s60, 2621440
  buffer_load_dwordx4 v[104:107], v6, s[16:19], s60 offen
  s_mov_b32 s60, 2883584
  buffer_load_dwordx4 v[108:111], v6, s[16:19], s60 offen
  s_mov_b32 s60, 3145728
  buffer_load_dwordx4 v[112:115], v6, s[16:19], s60 offen
  s_mov_b32 s60, 3407872
  buffer_load_dwordx4 v[116:119], v6, s[16:19], s60 offen
  s_cmp_lg_u32 s2, 0
  s_cbranch_scc1 W4_NOZ
  v_mov_b32 v20, 0
  v_mov_b32 v21, 0
  v_mov_b32 v22, 0
  v_mov_b32 v23, 0
  v_lshlrev_b32 v8, 4, v2
  s_mov_b32 s60, 2097152
  buffer_store_dwordx4 v[20:23], v8, s[20:23], s60 offen sc0 sc1
  s_mov_b32 s60, 2098176
  buffer_store_dwordx4 v[20:23], v8, s[20:23], s60 offen sc0 sc1
  s_mov_b32 s60, 2099200
  buffer_store_dwordx4 v[20:23], v8, s[20:23], s60 offen sc0 sc1
  s_mov_b32 s60, 2100224
  buffer_store_dwordx4 v[20:23], v8, s[20:23], s60 offen sc0 sc1
  s_mov_b32 s60, 2101248
  buffer_store_dwordx4 v[20:23], v8, s[20:23], s60 offen sc0 sc1
  s_mov_b32 s60, 2102272
  buffer_store_dwordx4 v[20:23], v8, s[20:23], s60 offen sc0 sc1
  s_mov_b32 s60, 2103296
  buffer_store_dwordx4 v[20:23], v8, s[20:23], s60 offen sc0 sc1
  s_mov_b32 s60, 2104320
  buffer_store_dwordx4 v[20:23], v8, s[20:23], s60 offen sc0 sc1
  s_mov_b32 s60, 2105344
  buffer_store_dwordx4 v[20:23], v8, s[20:23], s60 offen sc0 sc1
  s_mov_b32 s60, 2106368
  buffer_store_dwordx4 v[20:23], v8, s[20:23], s60 offen sc0 sc1
  s_mov_b32 s60, 2107392
  buffer_store_dwordx4 v[20:23], v8, s[20:23], s60 offen sc0 sc1
  s_mov_b32 s60, 2108416
  buffer_store_dwordx4 v[20:23], v8, s[20:23], s60 offen sc0 sc1
  s_mov_b32 s60, 2109440
  buffer_store_dwordx4 v[20:23], v8, s[20:23], s60 offen sc0 sc1
  s_mov_b32 s60, 2110464
  buffer_store_dwordx4 v[20:23], v8, s[20:23], s60 offen sc0 sc1
  s_mov_b32 s60, 2111488
  buffer_store_dwordx4 v[20:23], v8, s[20:23], s60 offen sc0 sc1
  s_mov_b32 s60, 2112512
  buffer_store_dwordx4 v[20:23], v8, s[20:23], s60 offen sc0 sc1
  s_mov_b32 s60, 2113536
  buffer_store_dwordx4 v[20:23], v8, s[20:23], s60 offen sc0 sc1
  s_mov_b32 s60, 2114560
  buffer_store_dwordx4 v[20:23], v8, s[20:23], s60 offen sc0 sc1
  s_mov_b32 s60, 2115584
  buffer_store_dwordx4 v[20:23], v8, s[20:23], s60 offen sc0 sc1
  s_mov_b32 s60, 2116608
  buffer_store_dwordx4 v[20:23], v8, s[20:23], s60 offen sc0 sc1
  s_mov_b32 s60, 2117632
  buffer_store_dwordx4 v[20:23], v8, s[20:23], s60 offen sc0 sc1
  s_mov_b32 s60, 2118656
  buffer_store_dwordx4 v[20:23], v8, s[20:23], s60 offen sc0 sc1
  s_mov_b32 s60, 2119680
  buffer_store_dwordx4 v[20:23], v8, s[20:23], s60 offen sc0 sc1
  s_mov_b32 s60, 2120704
  buffer_store_dwordx4 v[20:23], v8, s[20:23], s60 offen sc0 sc1
  s_mov_b32 s60, 2121728
  buffer_store_dwordx4 v[20:23], v8, s[20:23], s60 offen sc0 sc1
  s_mov_b32 s60, 2122752
  buffer_store_dwordx4 v[20:23], v8, s[20:23], s60 offen sc0 sc1
  s_mov_b32 s60, 2123776
  buffer_store_dwordx4 v[20:23], v8, s[20:23], s60 offen sc0 sc1
  s_mov_b32 s60, 2124800
  buffer_store_dwordx4 v[20:23], v8, s[20:23], s60 offen sc0 sc1
  s_mov_b32 s60, 2125824
  buffer_store_dwordx4 v[20:23], v8, s[20:23], s60 offen sc0 sc1
  s_mov_b32 s60, 2126848
  buffer_store_dwordx4 v[20:23], v8, s[20:23], s60 offen sc0 sc1
  s_mov_b32 s60, 2127872
  buffer_store_dwordx4 v[20:23], v8, s[20:23], s60 offen sc0 sc1
  s_mov_b32 s60, 2128896
  buffer_store_dwordx4 v[20:23], v8, s[20:23], s60 offen sc0 sc1
  s_mov_b32 s60, 2129920
  buffer_store_dwordx4 v[20:23], v8, s[20:23], s60 offen sc0 sc1
  s_mov_b32 s60, 2130944
  buffer_store_dwordx4 v[20:23], v8, s[20:23], s60 offen sc0 sc1
  s_mov_b32 s60, 2131968
  buffer_store_dwordx4 v[20:23], v8, s[20:23], s60 offen sc0 sc1
  s_mov_b32 s60, 2132992
  buffer_store_dwordx4 v[20:23], v8, s[20:23], s60 offen sc0 sc1
  s_mov_b32 s60, 2134016
  buffer_store_dwordx4 v[20:23], v8, s[20:23], s60 offen sc0 sc1
  s_mov_b32 s60, 2135040
  buffer_store_dwordx4 v[20:23], v8, s[20:23], s60 offen sc0 sc1
  s_mov_b32 s60, 2136064
  buffer_store_dwordx4 v[20:23], v8, s[20:23], s60 offen sc0 sc1
  s_mov_b32 s60, 2137088
  buffer_store_dwordx4 v[20:23], v8, s[20:23], s60 offen sc0 sc1
  s_mov_b32 s60, 2138112
  buffer_store_dwordx4 v[20:23], v8, s[20:23], s60 offen sc0 sc1
  s_mov_b32 s60, 2139136
  buffer_store_dwordx4 v[20:23], v8, s[20:23], s60 offen sc0 sc1
  s_mov_b32 s60, 2140160
  buffer_store_dwordx4 v[20:23], v8, s[20:23], s60 offen sc0 sc1
  s_mov_b32 s60, 2141184
  buffer_store_dwordx4 v[20:23], v8, s[20:23], s60 offen sc0 sc1
  s_mov_b32 s60, 2142208
  buffer_store_dwordx4 v[20:23], v8, s[20:23], s60 offen sc0 sc1
  s_mov_b32 s60, 2143232
  buffer_store_dwordx4 v[20:23], v8, s[20:23], s60 offen sc0 sc1
  s_mov_b32 s60, 2144256
  buffer_store_dwordx4 v[20:23], v8, s[20:23], s60 offen sc0 sc1
  s_mov_b32 s60, 2145280
  buffer_store_dwordx4 v[20:23], v8, s[20:23], s60 offen sc0 sc1
  s_waitcnt vmcnt(0)
  v_mov_b32 v9, 1
  v_mov_b32 v8, 0
  buffer_store_dword v9, v8, s[40:43], 0 offen offset:64 sc0 sc1
W4_NOZ:
  s_waitcnt vmcnt(14)
  v_lshlrev_b32 v10, 16, v10
  v_lshlrev_b32 v11, 16, v11
  v_lshlrev_b32 v12, 16, v12
  v_lshlrev_b32 v13, 16, v13
  v_lshlrev_b32 v14, 16, v14
  v_lshlrev_b32 v15, 16, v15
  v_lshlrev_b32 v16, 16, v16
  v_mov_b32 v17, v10
  v_add_f32 v17, v17, v11
  v_add_f32 v17, v17, v12
  v_add_f32 v17, v17, v13
  v_add_f32 v17, v17, v14
  v_add_f32 v17, v17, v15
  v_add_f32 v17, v17, v16
  s_nop 1
  v_add_f32 v17, v17, v17 quad_perm:[1,0,3,2] row_mask:0xf bank_mask:0xf
  s_nop 1
  v_add_f32 v17, v17, v17 quad_perm:[2,3,0,1] row_mask:0xf bank_mask:0xf
  s_nop 1
  v_add_f32 v17, v17, v17 row_ror:4 row_mask:0xf bank_mask:0xf
  s_nop 1
  v_add_f32 v17, v17, v17 row_ror:8 row_mask:0xf bank_mask:0xf
  s_nop 1
  v_readlane_b32 s56, v17, 0
  v_readlane_b32 s57, v17, 16
  v_readlane_b32 s58, v17, 32
  v_readlane_b32 s59, v17, 48
  s_nop 1
  v_mov_b32 v17, s56
  v_add_f32 v17, s57, v17
  v_add_f32 v17, s58, v17
  v_add_f32 v17, s59, v17
  v_mul_f32 v17, 0.002232142857142857, v17
  v_mov_b32 v18, 0
  v_sub_f32 v19, v10, v17
  v_fmac_f32 v18, v19, v19
  v_sub_f32 v19, v11, v17
  v_fmac_f32 v18, v19, v19
  v_sub_f32 v19, v12, v17
  v_fmac_f32 v18, v19, v19
  v_sub_f32 v19, v13, v17
  v_fmac_f32 v18, v19, v19
  v_sub_f32 v19, v14, v17
  v_fmac_f32 v18, v19, v19
  v_sub_f32 v19, v15, v17
  v_fmac_f32 v18, v19, v19
  v_sub_f32 v19, v16, v17
  v_fmac_f32 v18, v19, v19
  s_nop 1
  v_add_f32 v18, v18, v18 quad_perm:[1,0,3,2] row_mask:0xf bank_mask:0xf
  s_nop 1
  v_add_f32 v18, v18, v18 quad_perm:[2,3,0,1] row_mask:0xf bank_mask:0xf
  s_nop 1
  v_add_f32 v18, v18, v18 row_ror:4 row_mask:0xf bank_mask:0xf
  s_nop 1
  v_add_f32 v18, v18, v18 row_ror:8 row_mask:0xf bank_mask:0xf
  s_nop 1
  v_readlane_b32 s56, v18, 0
  v_readlane_b32 s57, v18, 16
  v_readlane_b32 s58, v18, 32
  v_readlane_b32 s59, v18, 48
  s_nop 1
  v_mov_b32 v18, s56
  v_add_f32 v18, s57, v18
  v_add_f32 v18, s58, v18
  v_add_f32 v18, s59, v18
  v_mul_f32 v18, 0.002232142857142857, v18
  v_cvt_pk_bf16_f32 v17, v17, v17
  v_lshlrev_b32 v17, 16, v17
  v_cvt_pk_bf16_f32 v18, v18, v18
  v_lshlrev_b32 v18, 16, v18
  v_add_f32 v18, 1e-05, v18
  v_cvt_pk_bf16_f32 v18, v18, v18
  v_lshlrev_b32 v18, 16, v18
  v_sqrt_f32 v18, v18
  s_nop 0
  v_cvt_pk_bf16_f32 v18, v18, v18
  v_lshlrev_b32 v18, 16, v18
  v_rcp_f32 v18, v18
  s_nop 0
  v_sub_f32 v10, v10, v17
  v_cvt_pk_bf16_f32 v10, v10, v10
  v_lshlrev_b32 v10, 16, v10
  v_mul_f32 v10, v10, v18
  v_cvt_pk_bf16_f32 v10, v10, v10
  v_lshlrev_b32 v10, 16, v10
  v_sub_f32 v11, v11, v17
  v_cvt_pk_bf16_f32 v11, v11, v11
  v_lshlrev_b32 v11, 16, v11
  v_mul_f32 v11, v11, v18
  v_cvt_pk_bf16_f32 v11, v11, v11
  v_lshlrev_b32 v11, 16, v11
  v_sub_f32 v12, v12, v17
  v_cvt_pk_bf16_f32 v12, v12, v12
  v_lshlrev_b32 v12, 16, v12
  v_mul_f32 v12, v12, v18
  v_cvt_pk_bf16_f32 v12, v12, v12
  v_lshlrev_b32 v12, 16, v12
  v_sub_f32 v13, v13, v17
  v_cvt_pk_bf16_f32 v13, v13, v13
  v_lshlrev_b32 v13, 16, v13
  v_mul_f32 v13, v13, v18
  v_cvt_pk_bf16_f32 v13, v13, v13
  v_lshlrev_b32 v13, 16, v13
  v_sub_f32 v14, v14, v17
  v_cvt_pk_bf16_f32 v14, v14, v14
  v_lshlrev_b32 v14, 16, v14
  v_mul_f32 v14, v14, v18
  v_cvt_pk_bf16_f32 v14, v14, v14
  v_lshlrev_b32 v14, 16, v14
  v_sub_f32 v15, v15, v17
  v_cvt_pk_bf16_f32 v15, v15, v15
  v_lshlrev_b32 v15, 16, v15
  v_mul_f32 v15, v15, v18
  v_cvt_pk_bf16_f32 v15, v15, v15
  v_lshlrev_b32 v15, 16, v15
  v_sub_f32 v16, v16, v17
  v_cvt_pk_bf16_f32 v16, v16, v16
  v_lshlrev_b32 v16, 16, v16
  v_mul_f32 v16, v16, v18
  v_cvt_pk_bf16_f32 v16, v16, v16
  v_lshlrev_b32 v16, 16, v16
  v_lshlrev_b32 v3, 2, v2
  ds_write_b32 v3, v10 offset:48192
  ds_write_b32 v3, v11 offset:48448
  ds_write_b32 v3, v12 offset:48704
  ds_write_b32 v3, v13 offset:48960
  ds_write_b32 v3, v14 offset:49216
  ds_write_b32 v3, v15 offset:49472
  ds_write_b32 v3, v16 offset:49728
  s_waitcnt lgkmcnt(0)
  v_lshlrev_b32 v8, 2, v4
  ds_read_b32 v160, v8 offset:48192
  ds_read_b32 v161, v8 offset:48320
  ds_read_b32 v162, v8 offset:48448
  ds_read_b32 v163, v8 offset:48576
  ds_read_b32 v164, v8 offset:48704
  ds_read_b32 v165, v8 offset:48832
  ds_read_b32 v166, v8 offset:48960
  ds_read_b32 v167, v8 offset:49088
  ds_read_b32 v168, v8 offset:49216
  ds_read_b32 v169, v8 offset:49344
  ds_read_b32 v170, v8 offset:49472
  ds_read_b32 v171, v8 offset:49600
  ds_read_b32 v172, v8 offset:49728
  ds_read_b32 v173, v8 offset:49856
  v_mov_b32 v40, 0
  v_mov_b32 v41, 0
  v_mov_b32 v42, 0
  v_mov_b32 v43, 0
  v_mov_b32 v44, 0
  v_mov_b32 v45, 0
  v_mov_b32 v46, 0
  v_mov_b32 v47, 0
  s_waitcnt vmcnt(0) lgkmcnt(0)
  v_lshlrev_b32 v50, 16, v64
  v_and_b32 v51, 0xffff0000, v64
  v_fmac_f32 v40, v160, v50
  v_fmac_f32 v41, v160, v51
  v_lshlrev_b32 v50, 16, v65
  v_and_b32 v51, 0xffff0000, v65
  v_fmac_f32 v42, v160, v50
  v_fmac_f32 v43, v160, v51
  v_lshlrev_b32 v50, 16, v66
  v_and_b32 v51, 0xffff0000, v66
  v_fmac_f32 v44, v160, v50
  v_fmac_f32 v45, v160, v51
  v_lshlrev_b32 v50, 16, v67
  v_and_b32 v51, 0xffff0000, v67
  v_fmac_f32 v46, v160, v50
  v_fmac_f32 v47, v160, v51
  v_lshlrev_b32 v50, 16, v68
  v_and_b32 v51, 0xffff0000, v68
  v_fmac_f32 v40, v161, v50
  v_fmac_f32 v41, v161, v51
  v_lshlrev_b32 v50, 16, v69
  v_and_b32 v51, 0xffff0000, v69
  v_fmac_f32 v42, v161, v50
  v_fmac_f32 v43, v161, v51
  v_lshlrev_b32 v50, 16, v70
  v_and_b32 v51, 0xffff0000, v70
  v_fmac_f32 v44, v161, v50
  v_fmac_f32 v45, v161, v51
  v_lshlrev_b32 v50, 16, v71
  v_and_b32 v51, 0xffff0000, v71
  v_fmac_f32 v46, v161, v50
  v_fmac_f32 v47, v161, v51
  v_lshlrev_b32 v50, 16, v72
  v_and_b32 v51, 0xffff0000, v72
  v_fmac_f32 v40, v162, v50
  v_fmac_f32 v41, v162, v51
  v_lshlrev_b32 v50, 16, v73
  v_and_b32 v51, 0xffff0000, v73
  v_fmac_f32 v42, v162, v50
  v_fmac_f32 v43, v162, v51
  v_lshlrev_b32 v50, 16, v74
  v_and_b32 v51, 0xffff0000, v74
  v_fmac_f32 v44, v162, v50
  v_fmac_f32 v45, v162, v51
  v_lshlrev_b32 v50, 16, v75
  v_and_b32 v51, 0xffff0000, v75
  v_fmac_f32 v46, v162, v50
  v_fmac_f32 v47, v162, v51
  v_lshlrev_b32 v50, 16, v76
  v_and_b32 v51, 0xffff0000, v76
  v_fmac_f32 v40, v163, v50
  v_fmac_f32 v41, v163, v51
  v_lshlrev_b32 v50, 16, v77
  v_and_b32 v51, 0xffff0000, v77
  v_fmac_f32 v42, v163, v50
  v_fmac_f32 v43, v163, v51
  v_lshlrev_b32 v50, 16, v78
  v_and_b32 v51, 0xffff0000, v78
  v_fmac_f32 v44, v163, v50
  v_fmac_f32 v45, v163, v51
  v_lshlrev_b32 v50, 16, v79
  v_and_b32 v51, 0xffff0000, v79
  v_fmac_f32 v46, v163, v50
  v_fmac_f32 v47, v163, v51
  v_lshlrev_b32 v50, 16, v80
  v_and_b32 v51, 0xffff0000, v80
  v_fmac_f32 v40, v164, v50
  v_fmac_f32 v41, v164, v51
  v_lshlrev_b32 v50, 16, v81
  v_and_b32 v51, 0xffff0000, v81
  v_fmac_f32 v42, v164, v50
  v_fmac_f32 v43, v164, v51
  v_lshlrev_b32 v50, 16, v82
  v_and_b32 v51, 0xffff0000, v82
  v_fmac_f32 v44, v164, v50
  v_fmac_f32 v45, v164, v51
  v_lshlrev_b32 v50, 16, v83
  v_and_b32 v51, 0xffff0000, v83
  v_fmac_f32 v46, v164, v50
  v_fmac_f32 v47, v164, v51
  v_lshlrev_b32 v50, 16, v84
  v_and_b32 v51, 0xffff0000, v84
  v_fmac_f32 v40, v165, v50
  v_fmac_f32 v41, v165, v51
  v_lshlrev_b32 v50, 16, v85
  v_and_b32 v51, 0xffff0000, v85
  v_fmac_f32 v42, v165, v50
  v_fmac_f32 v43, v165, v51
  v_lshlrev_b32 v50, 16, v86
  v_and_b32 v51, 0xffff0000, v86
  v_fmac_f32 v44, v165, v50
  v_fmac_f32 v45, v165, v51
  v_lshlrev_b32 v50, 16, v87
  v_and_b32 v51, 0xffff0000, v87
  v_fmac_f32 v46, v165, v50
  v_fmac_f32 v47, v165, v51
  v_lshlrev_b32 v50, 16, v88
  v_and_b32 v51, 0xffff0000, v88
  v_fmac_f32 v40, v166, v50
  v_fmac_f32 v41, v166, v51
  v_lshlrev_b32 v50, 16, v89
  v_and_b32 v51, 0xffff0000, v89
  v_fmac_f32 v42, v166, v50
  v_fmac_f32 v43, v166, v51
  v_lshlrev_b32 v50, 16, v90
  v_and_b32 v51, 0xffff0000, v90
  v_fmac_f32 v44, v166, v50
  v_fmac_f32 v45, v166, v51
  v_lshlrev_b32 v50, 16, v91
  v_and_b32 v51, 0xffff0000, v91
  v_fmac_f32 v46, v166, v50
  v_fmac_f32 v47, v166, v51
  v_lshlrev_b32 v50, 16, v92
  v_and_b32 v51, 0xffff0000, v92
  v_fmac_f32 v40, v167, v50
  v_fmac_f32 v41, v167, v51
  v_lshlrev_b32 v50, 16, v93
  v_and_b32 v51, 0xffff0000, v93
  v_fmac_f32 v42, v167, v50
  v_fmac_f32 v43, v167, v51
  v_lshlrev_b32 v50, 16, v94
  v_and_b32 v51, 0xffff0000, v94
  v_fmac_f32 v44, v167, v50
  v_fmac_f32 v45, v167, v51
  v_lshlrev_b32 v50, 16, v95
  v_and_b32 v51, 0xffff0000, v95
  v_fmac_f32 v46, v167, v50
  v_fmac_f32 v47, v167, v51
  v_lshlrev_b32 v50, 16, v96
  v_and_b32 v51, 0xffff0000, v96
  v_fmac_f32 v40, v168, v50
  v_fmac_f32 v41, v168, v51
  v_lshlrev_b32 v50, 16, v97
  v_and_b32 v51, 0xffff0000, v97
  v_fmac_f32 v42, v168, v50
  v_fmac_f32 v43, v168, v51
  v_lshlrev_b32 v50, 16, v98
  v_and_b32 v51, 0xffff0000, v98
  v_fmac_f32 v44, v168, v50
  v_fmac_f32 v45, v168, v51
  v_lshlrev_b32 v50, 16, v99
  v_and_b32 v51, 0xffff0000, v99
  v_fmac_f32 v46, v168, v50
  v_fmac_f32 v47, v168, v51
  v_lshlrev_b32 v50, 16, v100
  v_and_b32 v51, 0xffff0000, v100
  v_fmac_f32 v40, v169, v50
  v_fmac_f32 v41, v169, v51
  v_lshlrev_b32 v50, 16, v101
  v_and_b32 v51, 0xffff0000, v101
  v_fmac_f32 v42, v169, v50
  v_fmac_f32 v43, v169, v51
  v_lshlrev_b32 v50, 16, v102
  v_and_b32 v51, 0xffff0000, v102
  v_fmac_f32 v44, v169, v50
  v_fmac_f32 v45, v169, v51
  v_lshlrev_b32 v50, 16, v103
  v_and_b32 v51, 0xffff0000, v103
  v_fmac_f32 v46, v169, v50
  v_fmac_f32 v47, v169, v51
  v_lshlrev_b32 v50, 16, v104
  v_and_b32 v51, 0xffff0000, v104
  v_fmac_f32 v40, v170, v50
  v_fmac_f32 v41, v170, v51
  v_lshlrev_b32 v50, 16, v105
  v_and_b32 v51, 0xffff0000, v105
  v_fmac_f32 v42, v170, v50
  v_fmac_f32 v43, v170, v51
  v_lshlrev_b32 v50, 16, v106
  v_and_b32 v51, 0xffff0000, v106
  v_fmac_f32 v44, v170, v50
  v_fmac_f32 v45, v170, v51
  v_lshlrev_b32 v50, 16, v107
  v_and_b32 v51, 0xffff0000, v107
  v_fmac_f32 v46, v170, v50
  v_fmac_f32 v47, v170, v51
  v_lshlrev_b32 v50, 16, v108
  v_and_b32 v51, 0xffff0000, v108
  v_fmac_f32 v40, v171, v50
  v_fmac_f32 v41, v171, v51
  v_lshlrev_b32 v50, 16, v109
  v_and_b32 v51, 0xffff0000, v109
  v_fmac_f32 v42, v171, v50
  v_fmac_f32 v43, v171, v51
  v_lshlrev_b32 v50, 16, v110
  v_and_b32 v51, 0xffff0000, v110
  v_fmac_f32 v44, v171, v50
  v_fmac_f32 v45, v171, v51
  v_lshlrev_b32 v50, 16, v111
  v_and_b32 v51, 0xffff0000, v111
  v_fmac_f32 v46, v171, v50
  v_fmac_f32 v47, v171, v51
  v_lshlrev_b32 v50, 16, v112
  v_and_b32 v51, 0xffff0000, v112
  v_fmac_f32 v40, v172, v50
  v_fmac_f32 v41, v172, v51
  v_lshlrev_b32 v50, 16, v113
  v_and_b32 v51, 0xffff0000, v113
  v_fmac_f32 v42, v172, v50
  v_fmac_f32 v43, v172, v51
  v_lshlrev_b32 v50, 16, v114
  v_and_b32 v51, 0xffff0000, v114
  v_fmac_f32 v44, v172, v50
  v_fmac_f32 v45, v172, v51
  v_lshlrev_b32 v50, 16, v115
  v_and_b32 v51, 0xffff0000, v115
  v_fmac_f32 v46, v172, v50
  v_fmac_f32 v47, v172, v51
  v_lshlrev_b32 v50, 16, v116
  v_and_b32 v51, 0xffff0000, v116
  v_fmac_f32 v40, v173, v50
  v_fmac_f32 v41, v173, v51
  v_lshlrev_b32 v50, 16, v117
  v_and_b32 v51, 0xffff0000, v117
  v_fmac_f32 v42, v173, v50
  v_fmac_f32 v43, v173, v51
  v_lshlrev_b32 v50, 16, v118
  v_and_b32 v51, 0xffff0000, v118
  v_fmac_f32 v44, v173, v50
  v_fmac_f32 v45, v173, v51
  v_lshlrev_b32 v50, 16, v119
  v_and_b32 v51, 0xffff0000, v119
  v_fmac_f32 v46, v173, v50
  v_fmac_f32 v47, v173, v51
  v_lshlrev_b32 v8, 6, v4
  v_lshl_add_u32 v8, v5, 5, v8
  ds_write_b128 v8, v[40:43] offset:50240
  ds_write_b128 v8, v[44:47] offset:50256
  s_waitcnt lgkmcnt(0)
  v_and_b32 v8, 15, v2
  v_lshrrev_b32 v9, 4, v2
  v_lshlrev_b32 v9, 9, v9
  v_lshl_add_u32 v8, v8, 2, v9
  ds_read_b32 v40, v8 offset:50240
  ds_read_b32 v41, v8 offset:50304
  ds_read_b32 v42, v8 offset:50368
  ds_read_b32 v43, v8 offset:50432
  ds_read_b32 v44, v8 offset:50496
  ds_read_b32 v45, v8 offset:50560
  ds_read_b32 v46, v8 offset:50624
  ds_read_b32 v47, v8 offset:50688
  s_waitcnt lgkmcnt(0)
  v_add_f32 v40, v40, v41
  v_add_f32 v40, v40, v42
  v_add_f32 v40, v40, v43
  v_add_f32 v40, v40, v44
  v_add_f32 v40, v40, v45
  v_add_f32 v40, v40, v46
  v_add_f32 v40, v40, v47
  v_lshlrev_b32 v8, 2, v2
  ds_write_b32 v8, v40 offset:52288
  s_waitcnt lgkmcnt(0)
  v_and_b32 v8, 15, v2
  v_lshlrev_b32 v8, 2, v8
  ds_read_b32 v40, v8 offset:52288
  ds_read_b32 v41, v8 offset:52352
  ds_read_b32 v42, v8 offset:52416
  ds_read_b32 v43, v8 offset:52480
  s_waitcnt lgkmcnt(0)
  v_add_f32 v40, v40, v41
  v_add_f32 v42, v42, v43
  v_add_f32 v40, v40, v42
  v_cvt_pk_bf16_f32 v40, v40, v40
  v_and_b32 v8, 15, v2
  v_lshlrev_b32 v8, 1, v8
  s_lshl_b32 s3, s2, 5
  v_add_u32 v8, s3, v8
  v_cmp_gt_u32 vcc, 16, v2
  s_and_saveexec_b64 s[92:93], vcc
  buffer_store_short v40, v8, s[20:23], 0 offen offset:0 sc0 sc1
  s_or_b64 exec, exec, s[92:93]
  s_waitcnt vmcnt(0)
  v_mov_b32 v60, 1
  v_mov_b32 v6, 0
  s_lshl_b32 s61, s90, 2
  s_mov_b64 exec, 1
  buffer_atomic_add v60, v6, s[40:43], s61 offen sc1
  s_mov_b64 exec, -1
  s_barrier
  v_mov_b32 v6, 0
P_Q:
  buffer_load_dword v10, v6, s[40:43], s61 offen sc0 sc1
  s_waitcnt vmcnt(0)
  v_readfirstlane_b32 s60, v10
  s_cmp_ge_u32 s60, 32
  s_cbranch_scc1 P_Q_D
  s_sleep 2
  s_branch P_Q
P_Q_D:
  s_lshl_b32 s60, s90, 10
  s_add_u32 s60, s60, 0
  v_lshlrev_b32 v8, 4, v2
  buffer_load_dwordx4 v[40:43], v8, s[20:23], s60 offen sc0 sc1
  s_waitcnt vmcnt(0)
  ds_write_b128 v8, v[40:43] offset:37120
  s_waitcnt lgkmcnt(0)
  s_barrier
END:
  s_endpgm
.section .rodata,"a"
.p2align 6
.amdhsa_kernel parallel_sum__sliding_block_cached__mixer_token_mlp__decode_kernel
  .amdhsa_next_free_vgpr 212
  .amdhsa_next_free_sgpr 96
  .amdhsa_accum_offset 212
  .amdhsa_group_segment_fixed_size 0
  .amdhsa_kernarg_size 104
  .amdhsa_user_sgpr_count 2
  .amdhsa_user_sgpr_kernarg_segment_ptr 1
  .amdhsa_system_sgpr_workgroup_id_x 1
.end_amdhsa_kernel
```
